```python
import torch

def _softmax(x, axis=-1):
    return torch.softmax(x, dim=axis)

def _gelu(x):
    return torch.nn.functional.gelu(x, approximate='tanh')

def _silu(x):
    return torch.nn.functional.silu(x)

def _sigmoid(x):
    return torch.sigmoid(x)

def _layernorm(x, axis=-1, eps=1e-05):
    m = x.mean(dim=axis, keepdim=True)
    v = x.var(dim=axis, keepdim=True, unbiased=False)
    return (x - m) / torch.sqrt(v + eps)

def _scatter_add(tgt, idx, src, axis=0):
    return tgt.clone().index_add_(axis, idx, src)

def _segment_sum(src, seg, n):
    out = torch.zeros((n,) + src.shape[1:], dtype=src.dtype)
    return out.index_add_(0, seg, src)

def _pad(x, pw):
    flat = tuple((v for pair in reversed(pw) for v in pair))
    return torch.nn.functional.pad(x, flat)
kernel_name = 'adaLN_cond__grouped_kv_mqa__dense_activation_silu__prompt'

def setup_inputs():

    _w = lambda a: (lambda t: t.to(torch.bfloat16) if t.is_floating_point() else t)(torch.as_tensor(a))

    def _A_setup():
        B, S, D, H = (1, 2048, 512, 32)
        Dh = D // H
        return {'x': _w((lambda *s: torch.randn(*s, dtype=torch.bfloat16) * 0.05)(B, S, D)), 'wq': _w((lambda *s: torch.randn(*s, dtype=torch.bfloat16) * 0.05)(D, H * Dh)), 'wk': _w((lambda *s: torch.randn(*s, dtype=torch.bfloat16) * 0.05)(D, Dh)), 'wv': _w((lambda *s: torch.randn(*s, dtype=torch.bfloat16) * 0.05)(D, Dh)), 'wo': _w((lambda *s: torch.randn(*s, dtype=torch.bfloat16) * 0.05)(H * Dh, D))}
    _A_in = _A_setup()

    def _B_setup():
        B, S, D, F = (1, 2048, 512, 1376)
        return {'x': _w((lambda *s: torch.randn(*s, dtype=torch.bfloat16) * 0.05)(B, S, D)), 'w1': _w((lambda *s: torch.randn(*s, dtype=torch.bfloat16) * 3.2)(D, F) * D ** (-0.5)), 'w2': _w((lambda *s: torch.randn(*s, dtype=torch.bfloat16) * 1.6)(F, D) * F ** (-0.5))}
    _B_in = _B_setup()
    return {'A_x': _A_in['x'], 'A_wq': _A_in['wq'], 'A_wk': _A_in['wk'], 'A_wv': _A_in['wv'], 'A_wo': _A_in['wo'], 'B_x': _B_in['x'], 'B_w1': _B_in['w1'], 'B_w2': _B_in['w2'], 'c': _w((lambda *s: torch.randn(*s, dtype=torch.bfloat16) * 0.1)(1, 512) * 8.0), 'w_mod': _w((lambda *s: torch.randn(*s, dtype=torch.bfloat16) * 0.1)(512, 6 * 512) * 512 ** (-0.5) * 8.0)}

def reference(A_x, A_wq, A_wk, A_wv, A_wo, B_x, B_w1, B_w2, c, w_mod):

    def _A_ref(x, wq, wk, wv, wo):
        B, S, D = x.shape
        H = 32
        Dh = D // H
        q = (lambda x, *d: x.permute(*d))((x @ wq).reshape(B, S, H, Dh), 0, 2, 1, 3)
        k = x @ wk
        v = x @ wv
        scores = torch.einsum('bhqd,bkd->bhqk', q, k) * Dh ** (-0.5)
        p = _softmax(scores, axis=-1)
        o = torch.einsum('bhqk,bkd->bhqd', p, v)
        return (lambda x, *d: x.permute(*d))(o, 0, 2, 1, 3).reshape(B, S, H * Dh) @ wo

    def _B_ref(x, w1, w2):
        h = torch.einsum('bsd,df->bsf', x, w1)
        h = _silu(h)
        out = torch.einsum('bsf,fd->bsd', h, w2)
        return out
    x = A_x
    mod = (_silu(c) @ w_mod).reshape(c.shape[0], 6, 1, -1)
    sa, ca, ga, sb, cb, gb = (mod[:, 0].clone(), mod[:, 1].clone(), mod[:, 2].clone(), mod[:, 3].clone(), mod[:, 4].clone(), mod[:, 5].clone())
    h = _layernorm(x, axis=-1) * (1 + ca) + sa
    x = x + ga * _A_ref(h, A_wq, A_wk, A_wv, A_wo)
    h = _layernorm(x, axis=-1) * (1 + cb) + sb
    x = x + gb * _B_ref(h, B_w1, B_w2)
    return x
```

```asm
; @launch grid=(256,1,1) block=(512,1,1) lds=163840
.amdgcn_target "amdgcn-amd-amdhsa--gfx950"
.text
.globl adaLN_cond__grouped_kv_mqa__dense_activation_silu__prompt_kernel
.p2align 8
.type adaLN_cond__grouped_kv_mqa__dense_activation_silu__prompt_kernel,@function
adaLN_cond__grouped_kv_mqa__dense_activation_silu__prompt_kernel:
    s_load_dwordx2 s[52:53], s[0:1], 72
    s_load_dwordx2 s[48:49], s[0:1], 64
    s_load_dwordx2 s[60:61], s[0:1], 96
    s_load_dwordx2 s[32:33], s[0:1], 0
    s_load_dwordx2 s[36:37], s[0:1], 8
    s_load_dwordx2 s[56:57], s[0:1], 80
    v_lshrrev_b32 v1, 6, v0
    v_and_b32 v0, 63, v0
    v_readfirstlane_b32 s64, v1
    v_lshlrev_b32 v0, 4, v0
    s_cmp_ge_u32 s2, 256
    s_cbranch_scc1 L_exit
    s_and_b32 s65, s2, 7
    s_lshl_b32 s65, s65, 5
    s_lshr_b32 s72, s2, 3
    s_add_u32 s65, s65, s72
    s_and_b32 s69, s64, 3
    s_cmp_eq_u32 s64, 1
    s_cselect_b32 s72, 16, 24
    s_cmp_lt_u32 s64, 3
    s_cselect_b32 s72, s72, 32
    s_cselect_b32 s42, 1, 32
    s_load_dwordx2 s[40:41], s[0:1], s72
    s_lshl_b32 s42, s42, 14
    s_mov_b32 s43, 0x20000
    s_lshl_b32 s100, s65, 2
    s_add_u32 s100, s100, s69
    s_cmp_lt_u32 s100, 344
    s_cselect_b32 s72, 56, 48
    s_load_dwordx2 s[44:45], s[0:1], s72
    s_and_b32 s66, s65, 7
    s_lshr_b32 s67, s65, 3
    s_and_b32 s68, s65, 15
    s_mov_b32 s54, 3145728
    s_mov_b32 s55, 0x20000
    s_mov_b32 s50, 1024
    s_mov_b32 s51, 0x20000
    s_mov_b32 s62, 19922944
    s_mov_b32 s63, 0x20000
    s_mov_b32 s34, 2097152
    s_mov_b32 s35, 0x20000
    s_mov_b32 s38, 524288
    s_mov_b32 s39, 0x20000
    s_mov_b32 s58, 2097152
    s_mov_b32 s59, 0x20000
    s_mov_b32 s46, 1409024
    s_mov_b32 s47, 0x20000
    s_mov_b32 s101, 0
    s_mov_b32 s29, 0
    s_cmp_eq_u32 s64, 0
    s_cbranch_scc0 L_nomod0
    s_lshr_b32 s72, s65, 6
    s_mul_i32 s73, s72, 786432
    s_and_b32 s74, s65, 63
    s_lshl_b32 s74, s74, 5
    s_add_u32 s73, s73, s74
    s_lshl_b32 s72, s72, 8
    v_lshrrev_b32 v8, 5, v0
    v_mul_u32_u24 v8, 6144, v8
    v_and_b32 v9, 16, v0
    v_add_u32 v8, v8, v9
    v_lshrrev_b32 v9, 2, v0
    v_mov_b32 v4, -1
    v_mov_b32 v5, -1
    v_mov_b32 v6, -1
    v_mov_b32 v7, -1
    s_mul_i32 s74, s65, 640
    s_add_u32 s74, s74, 65536
    s_mov_b32 m0, 143360
    s_waitcnt lgkmcnt(0)
    s_mov_b32 exec_hi, 0xff
    buffer_store_dwordx4 v[4:7], v0, s[60:63], s74 offen sc1
    s_mov_b32 exec_hi, -1
    buffer_load_dword v10, v9, s[48:51], s72 offen
    buffer_load_dwordx4 v8, s[52:55], s73 offen lds
    s_add_u32 m0, m0, 1024
    s_add_u32 s73, s73, 196608
    buffer_load_dwordx4 v8, s[52:55], s73 offen lds
    s_add_u32 m0, m0, 1024
    s_add_u32 s73, s73, 196608
    buffer_load_dwordx4 v8, s[52:55], s73 offen lds
    s_add_u32 m0, m0, 1024
    s_add_u32 s73, s73, 196608
    buffer_load_dwordx4 v8, s[52:55], s73 offen lds
    s_load_dword s71, s[60:61], 0
    s_branch L_b0
L_nomod0:
    s_getpc_b64 s[80:81]
L_pc0:
    s_lshr_b32 s74, s2, 3
    s_mul_i32 s74, s74, 7
    s_add_u32 s74, s74, s64
    s_lshl_b32 s74, s74, 8
    s_min_u32 s74, s74, L_codeend-L_pc0
    v_and_b32 v4, 16, v0
    v_lshlrev_b32 v4, 3, v4
    v_add_u32 v4, s74, v4
    global_load_dword v251, v4, s[80:81]
    s_waitcnt lgkmcnt(0)
    s_load_dword s71, s[60:61], 0
    s_cmp_lt_u32 s64, 3
    s_cbranch_scc1 L_p1_12
    s_cmp_eq_u32 s64, 3
    s_cbranch_scc1 L_p1_3
    s_cmp_eq_u32 s64, 4
    s_cbranch_scc0 L_p1_567
    s_add_u32 s76, s65, s69
    s_and_b32 s76, s76, 3
    s_and_b32 s77, s65, 0xfc
    s_add_u32 s76, s76, s77
    s_lshl_b32 s76, s76, 13
    buffer_load_dwordx4 v[32:35], v0, s[32:35], s76 offen offset:0
    buffer_load_dwordx4 v[36:39], v0, s[32:35], s76 offen offset:1024
    buffer_load_dwordx4 v[40:43], v0, s[32:35], s76 offen offset:2048
    buffer_load_dwordx4 v[44:47], v0, s[32:35], s76 offen offset:3072
    s_add_u32 s76, s76, 4096
    buffer_load_dwordx4 v[48:51], v0, s[32:35], s76 offen offset:0
    buffer_load_dwordx4 v[52:55], v0, s[32:35], s76 offen offset:1024
    buffer_load_dwordx4 v[56:59], v0, s[32:35], s76 offen offset:2048
    buffer_load_dwordx4 v[60:63], v0, s[32:35], s76 offen offset:3072
    s_branch L_b0
L_p1_567:
    s_cmp_eq_u32 s64, 7
    s_cbranch_scc1 L_p1_7
    s_bfe_u32 s74, s65, 0x30002
    s_lshl_b32 s74, s74, 16
    s_and_b32 s75, s65, 3
    s_lshl_b32 s75, s75, 1
    s_add_u32 s75, s75, s64
    s_sub_u32 s75, s75, 5
    s_lshl_b32 s75, s75, 7
    s_add_u32 s74, s74, s75
    v_lshlrev_b32 v4, 6, v0
    buffer_load_dword v250, v4, s[36:39], s74 offen
    s_branch L_b0
L_p1_7:
    v_bfe_u32 v249, v0, 5, 2
    v_lshlrev_b32 v249, 12, v249
    v_and_b32 v250, 16, v0
    v_lshl_add_u32 v249, v250, 3, v249
    s_lshr_b32 s72, s65, 4
    s_lshl_b32 s72, s72, 8
    s_add_u32 s72, s72, 4096
    buffer_load_dword v250, v249, s[60:63], s72 offen sc1
    v_mov_b32 v4, 0
    v_mov_b32 v5, 0
    v_mov_b32 v6, 0
    v_mov_b32 v7, 0
    v_add_u32 v12, 132096, v0
    ds_write_b128 v12, v[4:7]
    v_mov_b32 v8, -1
    v_mov_b32 v9, -1
    v_mov_b32 v10, -1
    v_mov_b32 v11, -1
    v_lshrrev_b32 v12, 1, v0
    v_add_u32 v12, 149504, v12
    ds_write_b64 v12, v[8:9]
    v_add_u32 v12, 133120, v0
    ds_write_b32 v12, v8 offset:0
    ds_write_b32 v12, v8 offset:1024
    ds_write_b32 v12, v8 offset:2048
    ds_write_b32 v12, v8 offset:3072
    ds_write_b32 v12, v8 offset:4096
    ds_write_b32 v12, v8 offset:5120
    ds_write_b32 v12, v8 offset:6144
    ds_write_b32 v12, v8 offset:7168
    s_waitcnt lgkmcnt(0)
    s_branch L_b0
L_p1_12:
    s_lshr_b32 s74, s2, 3
    s_lshl_b32 s74, s74, 9
    v_lshrrev_b32 v4, 1, v0
    buffer_load_dword v250, v4, s[40:43], s74 offen
    s_branch L_b0
L_p1_3:
    v_lshrrev_b32 v4, 6, v0
    v_lshlrev_b32 v4, 10, v4
    v_and_b32 v5, 0x30, v0
    v_add_u32 v4, v4, v5
    s_lshr_b32 s72, s65, 4
    s_lshl_b32 s72, s72, 15
    s_lshl_b32 s73, s68, 6
    s_mov_b32 m0, 141312
    s_add_u32 s72, s72, s73
    buffer_load_dwordx4 v4, s[40:43], s72 offen lds
    s_mov_b32 m0, 142336
    s_add_u32 s72, s72, 16384
    buffer_load_dwordx4 v4, s[40:43], s72 offen lds
    s_lshr_b32 s72, s65, 7
    s_lshl_b32 s72, s72, 9
    v_lshrrev_b32 v9, 1, v0
    buffer_load_dwordx2 v[10:11], v9, s[48:51], s72 offen
L_b0:
    s_and_b32 s1, s65, 3
    v_mov_b32 v16, 0
    s_barrier
    s_cmp_lt_u32 s64, 4
    s_cbranch_scc0 L_st_s
    s_cmp_eq_u32 s64, 0
    s_cbranch_scc1 L_st_0
    s_cmp_eq_u32 s64, 3
    s_cbranch_scc0 L_a_pw
    v_lshrrev_b32 v4, 8, v0
    v_bfe_u32 v5, v0, 6, 2
    v_lshl_add_u32 v4, v4, 3, v5
    v_lshlrev_b32 v4, 6, v4
    v_bfe_u32 v5, v0, 4, 2
    v_lshl_add_u32 v4, v5, 3, v4
    v_add_u32 v4, 141312, v4
    s_waitcnt vmcnt(0)
    ds_read_b64_tr_b16 v[56:57], v4
    ds_read_b64_tr_b16 v[58:59], v4 offset:256
    ds_read_b64_tr_b16 v[60:61], v4 offset:32
    ds_read_b64_tr_b16 v[62:63], v4 offset:288
    v_lshlrev_b32 v12, 16, v10
    v_and_b32 v13, 0xffff0000, v10
    v_lshlrev_b32 v14, 16, v11
    v_and_b32 v15, 0xffff0000, v11
    v_mul_f32 v16, 0xbfb8aa3b, v12
    v_mul_f32 v17, 0xbfb8aa3b, v13
    v_mul_f32 v18, 0xbfb8aa3b, v14
    v_mul_f32 v19, 0xbfb8aa3b, v15
    v_exp_f32 v16, v16
    v_exp_f32 v17, v17
    v_exp_f32 v18, v18
    v_exp_f32 v19, v19
    v_add_f32 v16, 1.0, v16
    v_add_f32 v17, 1.0, v17
    v_add_f32 v18, 1.0, v18
    v_add_f32 v19, 1.0, v19
    v_rcp_f32 v16, v16
    v_rcp_f32 v17, v17
    v_rcp_f32 v18, v18
    v_rcp_f32 v19, v19
    v_mul_f32 v12, v12, v16
    v_mul_f32 v13, v13, v17
    v_mul_f32 v14, v14, v18
    v_mul_f32 v15, v15, v19
    v_cvt_pk_bf16_f32 v10, v12, v13
    v_cvt_pk_bf16_f32 v11, v14, v15
    v_add_u32 v9, 150272, v9
    ds_write_b64 v9, v[10:11]
L_a_pw:
    s_mov_b32 s98, 0
L_lw_1:
    v_mov_b32 v4, 132136
    ds_read_b32 v4, v4
    s_add_u32 s98, s98, 1
    s_cmp_gt_u32 s98, 1048576
    s_cbranch_scc1 L_end
    s_sleep 1
    s_waitcnt lgkmcnt(0)
    v_readfirstlane_b32 s79, v4
    s_nop 0
    s_cmp_ge_u32 s79, 1
    s_cbranch_scc0 L_lw_1
    s_branch L_a_ld
L_st_0:
    s_setprio 3
    s_mov_b32 s72, 143360
    v_and_b32 v4, 0x300, v0
    v_and_b32 v5, 0xf0, v0
    v_lshrrev_b32 v5, 1, v5
    v_add3_u32 v4, v4, v5, s72
    v_lshrrev_b32 v5, 8, v0
    v_lshlrev_b32 v5, 4, v5
    v_add_u32 v6, 150016, v5
    v_add_u32 v9, 150016, v9
    s_lshr_b32 s72, s65, 6
    s_lshl_b32 s72, s72, 12
    s_and_b32 s73, s65, 63
    s_lshl_b32 s73, s73, 6
    s_add_u32 s72, s72, s73
    s_add_u32 s72, s72, 32768
    s_waitcnt vmcnt(4) lgkmcnt(0)
    s_mul_i32 s70, s71, 0x9e3779b1
    s_add_u32 s70, s70, 0x7f4a7c15
    v_lshlrev_b32 v12, 16, v10
    v_and_b32 v13, 0xffff0000, v10
    v_mul_f32 v14, 0xbfb8aa3b, v12
    v_mul_f32 v15, 0xbfb8aa3b, v13
    v_exp_f32 v14, v14
    v_exp_f32 v15, v15
    v_add_f32 v14, 1.0, v14
    v_add_f32 v15, 1.0, v15
    v_rcp_f32 v14, v14
    v_rcp_f32 v15, v15
    v_mul_f32 v12, v12, v14
    v_mul_f32 v13, v13, v15
    v_cvt_pk_bf16_f32 v10, v12, v13
    ds_write_b32 v9, v10
    ds_read_b128 v[56:59], v6 offset:0
    ds_read_b128 v[60:63], v6 offset:64
    ds_read_b128 v[64:67], v6 offset:128
    ds_read_b128 v[68:71], v6 offset:192
    s_waitcnt vmcnt(3)
    ds_read_b64_tr_b16 v[40:41], v4 offset:0
    ds_read_b64_tr_b16 v[42:43], v4 offset:128
    s_waitcnt vmcnt(2)
    ds_read_b64_tr_b16 v[44:45], v4 offset:1024
    ds_read_b64_tr_b16 v[46:47], v4 offset:1152
    s_waitcnt vmcnt(1)
    ds_read_b64_tr_b16 v[48:49], v4 offset:2048
    ds_read_b64_tr_b16 v[50:51], v4 offset:2176
    s_waitcnt vmcnt(0)
    ds_read_b64_tr_b16 v[52:53], v4 offset:3072
    ds_read_b64_tr_b16 v[54:55], v4 offset:3200
    s_waitcnt lgkmcnt(6)
    v_mfma_f32_16x16x32_bf16 v[12:15], v[40:43], v[56:59], 0
    s_waitcnt lgkmcnt(4)
    v_mfma_f32_16x16x32_bf16 v[12:15], v[44:47], v[60:63], v[12:15]
    s_waitcnt lgkmcnt(2)
    v_mfma_f32_16x16x32_bf16 v[12:15], v[48:51], v[64:67], v[12:15]
    s_waitcnt lgkmcnt(0)
    v_mfma_f32_16x16x32_bf16 v[12:15], v[52:55], v[68:71], v[12:15]
    s_getreg_b32 s73, hwreg(HW_REG_XCC_ID)
    s_and_b32 s73, s73, 15
    s_xor_b32 s73, s73, s70
    s_lshl_b32 s74, s65, 5
    s_add_u32 s74, s74, 229376
    s_sub_u32 s74, s74, s72
    v_writelane_b32 v5, s74, 1
    v_mov_b32 v16, 0xff
    s_lshr_b32 s75, s70, 0
    v_bfi_b32 v12, v16, s75, v12
    s_lshr_b32 s75, s70, 8
    v_bfi_b32 v13, v16, s75, v13
    s_lshr_b32 s75, s70, 16
    v_bfi_b32 v14, v16, s75, v14
    s_lshr_b32 s75, s70, 24
    v_bfi_b32 v15, v16, s75, v15
    v_writelane_b32 v12, s73, 1
    s_mov_b32 exec_lo, 0x00010003
    s_mov_b32 exec_hi, 0x00010001
    buffer_store_dwordx4 v[12:15], v5, s[60:63], s72 offen sc1
    s_mov_b64 exec, -1
    v_mov_b32 v4, 132136
    v_mov_b32 v5, 1
    s_mov_b64 exec, 1
    ds_add_u32 v4, v5
    s_mov_b64 exec, -1
    s_setprio 0
L_a_ld:
    v_lshrrev_b32 v2, 9, v0
    v_and_b32 v3, 0x1f0, v0
    v_lshrrev_b32 v3, 1, v3
    v_lshl_add_u32 v1, v2, 12, v3
    s_lshl_b32 s76, s65, 13
    s_lshl_b32 s77, s64, 8
    s_add_u32 s76, s76, s77
    buffer_load_dwordx2 v[48:49], v1, s[32:35], s76 offen offset:0
    buffer_load_dwordx2 v[50:51], v1, s[32:35], s76 offen offset:1024
    buffer_load_dwordx2 v[52:53], v1, s[32:35], s76 offen offset:2048
    buffer_load_dwordx2 v[54:55], v1, s[32:35], s76 offen offset:3072
    v_mul_u32_u24 v1, 4160, v2
    s_add_u32 s77, s77, 65536
    v_add3_u32 v3, v3, v1, s77
    v_mov_b32 v29, 0
    s_waitcnt lgkmcnt(0)
    s_mul_i32 s70, s71, 0x9e3779b1
    s_add_u32 s70, s70, 0x7f4a7c15
    s_sub_u32 s72, s64, 1
    s_cmp_lt_u32 s72, 2
    s_cbranch_scc0 L_a_wq
    s_lshl_b32 s72, s72, 14
    s_add_u32 s72, s72, 98816
    s_mov_b32 m0, s72
    s_mov_b32 s73, 0
    buffer_load_dwordx4 v0, s[40:43], s73 offen offset:0 lds
    buffer_load_dwordx4 v0, s[40:43], s73 offen offset:1024 lds
    buffer_load_dwordx4 v0, s[40:43], s73 offen offset:2048 lds
    buffer_load_dwordx4 v0, s[40:43], s73 offen offset:3072 lds
    s_add_u32 m0, m0, 4096
    s_add_u32 s73, s73, 4096
    buffer_load_dwordx4 v0, s[40:43], s73 offen offset:0 lds
    buffer_load_dwordx4 v0, s[40:43], s73 offen offset:1024 lds
    buffer_load_dwordx4 v0, s[40:43], s73 offen offset:2048 lds
    buffer_load_dwordx4 v0, s[40:43], s73 offen offset:3072 lds
    s_add_u32 m0, m0, 4096
    s_add_u32 s73, s73, 4096
    buffer_load_dwordx4 v0, s[40:43], s73 offen offset:0 lds
    buffer_load_dwordx4 v0, s[40:43], s73 offen offset:1024 lds
    buffer_load_dwordx4 v0, s[40:43], s73 offen offset:2048 lds
    buffer_load_dwordx4 v0, s[40:43], s73 offen offset:3072 lds
    s_add_u32 m0, m0, 4096
    s_add_u32 s73, s73, 4096
    buffer_load_dwordx4 v0, s[40:43], s73 offen offset:0 lds
    buffer_load_dwordx4 v0, s[40:43], s73 offen offset:1024 lds
    buffer_load_dwordx4 v0, s[40:43], s73 offen offset:2048 lds
    buffer_load_dwordx4 v0, s[40:43], s73 offen offset:3072 lds
    v_and_b32 v26, 0x300, v0
    v_and_b32 v5, 0xf0, v0
    v_lshrrev_b32 v5, 1, v5
    v_add3_u32 v26, v26, v5, s72
    v_lshrrev_b32 v5, 8, v0
    v_lshlrev_b32 v5, 4, v5
    v_bfe_u32 v4, v0, 4, 3
    v_lshl_add_u32 v29, v4, 5, v5
    s_cmp_eq_u32 s64, 2
    s_cbranch_scc0 L_a_nv
    v_bfe_u32 v4, v0, 4, 2
    v_bfe_u32 v6, v0, 7, 1
    v_lshl_add_u32 v4, v6, 2, v4
    v_add_u32 v29, 256, v0
L_a_nv:
    v_mul_u32_u24 v28, 1040, v4
    v_add_u32 v28, v28, v5
    v_add_u32 v28, 65536, v28
    s_branch L_a_addr
L_a_wq:
    v_lshrrev_b32 v4, 8, v0
    v_lshlrev_b32 v26, 10, v4
    v_lshlrev_b32 v4, 6, v4
    v_xor_b32 v4, v4, v0
    v_and_b32 v4, 0xf0, v4
    v_add_u32 v26, v26, v4
    s_lshr_b32 s72, s64, 1
    s_lshl_b32 s89, s72, 15
    s_lshl_b32 s88, s72, 17
    s_lshl_b32 s72, s1, 8
    s_add_u32 s88, s88, s72
    s_mov_b32 m0, s89
    s_mov_b32 s72, 4
L_wq_2:
    buffer_load_dwordx4 v26, s[36:39], s88 offen lds
    s_add_u32 m0, m0, 1024
    s_add_u32 s88, s88, 4096
    buffer_load_dwordx4 v26, s[36:39], s88 offen lds
    s_add_u32 m0, m0, 1024
    s_add_u32 s88, s88, 4096
    buffer_load_dwordx4 v26, s[36:39], s88 offen lds
    s_add_u32 m0, m0, 1024
    s_add_u32 s88, s88, 4096
    buffer_load_dwordx4 v26, s[36:39], s88 offen lds
    s_add_u32 m0, m0, 1024
    s_add_u32 s88, s88, 4096
    buffer_load_dwordx4 v26, s[36:39], s88 offen lds
    s_add_u32 m0, m0, 1024
    s_add_u32 s88, s88, 4096
    buffer_load_dwordx4 v26, s[36:39], s88 offen lds
    s_add_u32 m0, m0, 1024
    s_add_u32 s88, s88, 4096
    buffer_load_dwordx4 v26, s[36:39], s88 offen lds
    s_add_u32 m0, m0, 1024
    s_add_u32 s88, s88, 4096
    buffer_load_dwordx4 v26, s[36:39], s88 offen lds
    s_add_u32 m0, m0, 1024
    s_add_u32 s88, s88, 4096
    s_sub_u32 s72, s72, 1
    s_cmp_lg_u32 s72, 0
    s_cbranch_scc1 L_wq_2
    s_add_u32 s88, s88, 131072
L_a_addr:
    v_bfe_u32 v4, v0, 8, 1
    v_bfe_u32 v5, v0, 6, 1
    v_lshl_add_u32 v4, v4, 1, v5
    v_mul_u32_u24 v30, 640, v4
    v_bfe_u32 v4, v0, 7, 1
    v_bfe_u32 v5, v0, 4, 2
    v_lshl_add_u32 v4, v4, 2, v5
    v_lshl_add_u32 v30, v4, 5, v30
    v_lshl_add_u32 v30, v2, 4, v30
    v_mul_u32_u24 v4, 640, v2
    v_and_b32 v5, 0x1f0, v0
    v_and_b32 v6, 0x1b0, v0
    v_cmp_lt_u32 vcc, 0x100, v6
    v_min_u32 v5, 0x100, v5
    v_add3_u32 v4, v4, v5, 64
    v_add_u32 v4, 192, v4
    v_mov_b32 v5, 0x7f000000
    v_cndmask_b32 v31, v4, v5, vcc
    s_mul_i32 s72, s64, 40960
    s_add_u32 s72, s72, 65536
    s_add_u32 s73, s65, 0
    s_and_b32 s73, s73, 7
    s_mul_i32 s73, s73, 5120
    s_add_u32 s80, s73, s72
    s_add_u32 s73, s65, 1
    s_and_b32 s73, s73, 7
    s_mul_i32 s73, s73, 5120
    s_add_u32 s81, s73, s72
    s_add_u32 s73, s65, 2
    s_and_b32 s73, s73, 7
    s_mul_i32 s73, s73, 5120
    s_add_u32 s82, s73, s72
    s_add_u32 s73, s65, 3
    s_and_b32 s73, s73, 7
    s_mul_i32 s73, s73, 5120
    s_add_u32 s83, s73, s72
    s_add_u32 s73, s65, 4
    s_and_b32 s73, s73, 7
    s_mul_i32 s73, s73, 5120
    s_add_u32 s84, s73, s72
    s_add_u32 s73, s65, 5
    s_and_b32 s73, s73, 7
    s_mul_i32 s73, s73, 5120
    s_add_u32 s85, s73, s72
    s_add_u32 s73, s65, 6
    s_and_b32 s73, s73, 7
    s_mul_i32 s73, s73, 5120
    s_add_u32 s86, s73, s72
    s_add_u32 s73, s65, 7
    s_and_b32 s73, s73, 7
    s_mul_i32 s73, s73, 5120
    s_add_u32 s87, s73, s72
    s_mov_b32 s98, 0
L_lw_3:
    v_mov_b32 v4, 132156
    ds_read_b32 v4, v4
    s_add_u32 s98, s98, 1
    s_cmp_gt_u32 s98, 1048576
    s_cbranch_scc1 L_end
    s_sleep 1
    s_waitcnt lgkmcnt(0)
    v_readfirstlane_b32 s79, v4
    s_nop 0
    s_cmp_ge_u32 s79, 1
    s_cbranch_scc0 L_lw_3
    v_lshlrev_b32 v4, 5, v2
    v_add_u32 v4, 132416, v4
    ds_read_b128 v[8:11], v4
    ds_read_b128 v[12:15], v4 offset:16
    s_waitcnt vmcnt(16)
    v_lshlrev_b32 v32, 16, v48
    v_and_b32 v33, 0xffff0000, v48
    v_lshlrev_b32 v34, 16, v49
    v_and_b32 v35, 0xffff0000, v49
    v_lshlrev_b32 v36, 16, v50
    v_and_b32 v37, 0xffff0000, v50
    v_lshlrev_b32 v38, 16, v51
    v_and_b32 v39, 0xffff0000, v51
    v_lshlrev_b32 v40, 16, v52
    v_and_b32 v41, 0xffff0000, v52
    v_lshlrev_b32 v42, 16, v53
    v_and_b32 v43, 0xffff0000, v53
    v_lshlrev_b32 v44, 16, v54
    v_and_b32 v45, 0xffff0000, v54
    v_lshlrev_b32 v46, 16, v55
    v_and_b32 v47, 0xffff0000, v55
    s_waitcnt lgkmcnt(0)
    v_pk_fma_f32 v[32:33], v[32:33], v[8:9], v[8:9] op_sel:[0,0,1] op_sel_hi:[1,0,1]
    v_pk_fma_f32 v[34:35], v[34:35], v[8:9], v[8:9] op_sel:[0,0,1] op_sel_hi:[1,0,1]
    v_pk_fma_f32 v[36:37], v[36:37], v[10:11], v[10:11] op_sel:[0,0,1] op_sel_hi:[1,0,1]
    v_pk_fma_f32 v[38:39], v[38:39], v[10:11], v[10:11] op_sel:[0,0,1] op_sel_hi:[1,0,1]
    v_pk_fma_f32 v[40:41], v[40:41], v[12:13], v[12:13] op_sel:[0,0,1] op_sel_hi:[1,0,1]
    v_pk_fma_f32 v[42:43], v[42:43], v[12:13], v[12:13] op_sel:[0,0,1] op_sel_hi:[1,0,1]
    v_pk_fma_f32 v[44:45], v[44:45], v[14:15], v[14:15] op_sel:[0,0,1] op_sel_hi:[1,0,1]
    v_pk_fma_f32 v[46:47], v[46:47], v[14:15], v[14:15] op_sel:[0,0,1] op_sel_hi:[1,0,1]
    s_waitcnt vmcnt(0)
    v_mov_b32 v4, 132152
    v_mov_b32 v5, 1
    s_mov_b64 exec, 1
    ds_add_u32 v4, v5
    s_mov_b64 exec, -1
    s_mov_b32 s98, 0
L_lw_4:
    v_mov_b32 v4, 132152
    ds_read_b32 v4, v4
    s_add_u32 s98, s98, 1
    s_cmp_gt_u32 s98, 1048576
    s_cbranch_scc1 L_end
    s_sleep 1
    s_waitcnt lgkmcnt(0)
    v_readfirstlane_b32 s79, v4
    s_nop 0
    s_cmp_ge_u32 s79, 4
    s_cbranch_scc0 L_lw_4
    s_bfe_u32 s76, s70, 0x80000
    s_bfe_u32 s77, s70, 0x80008
    s_bfe_u32 s78, s70, 0x80010
    s_bfe_u32 s79, s70, 0x80018
    v_and_b32 v1, 0x1f0, v0
    v_lshl_add_u32 v1, v2, 11, v1
    s_lshl_b32 s74, s64, 9
    s_add_u32 s72, s74, 32768
    s_add_u32 s73, s72, 4096
    s_add_u32 s74, s74, 157696
    v_add_u32 v21, s74, v1
    s_add_u32 s74, s72, 8192
    s_add_u32 s75, s72, 12288
    v_cvt_f32_u32 v22, v2
    v_mov_b32 v24, 132140
    v_mov_b32 v25, 1
    s_mov_b32 s98, 0
    s_setprio 3
    buffer_load_dwordx4 v[4:7], v1, s[60:63], s72 offen sc1
    buffer_load_dwordx4 v[8:11], v1, s[60:63], s73 offen sc1
    buffer_load_dwordx4 v[12:15], v1, s[60:63], s74 offen sc1
    buffer_load_dwordx4 v[16:19], v1, s[60:63], s75 offen sc1
    s_sub_u32 s90, s64, 1
    s_cmp_lt_u32 s90, 2
    s_cbranch_scc0 L_poll1w
    ds_read_b64_tr_b16 v[128:129], v26 offset:0
    ds_read_b64_tr_b16 v[130:131], v26 offset:128
    ds_read_b64_tr_b16 v[132:133], v26 offset:1024
    ds_read_b64_tr_b16 v[134:135], v26 offset:1152
    ds_read_b64_tr_b16 v[136:137], v26 offset:2048
    ds_read_b64_tr_b16 v[138:139], v26 offset:2176
    ds_read_b64_tr_b16 v[140:141], v26 offset:3072
    ds_read_b64_tr_b16 v[142:143], v26 offset:3200
    ds_read_b64_tr_b16 v[144:145], v26 offset:4096
    ds_read_b64_tr_b16 v[146:147], v26 offset:4224
    ds_read_b64_tr_b16 v[148:149], v26 offset:5120
    ds_read_b64_tr_b16 v[150:151], v26 offset:5248
    ds_read_b64_tr_b16 v[152:153], v26 offset:6144
    ds_read_b64_tr_b16 v[154:155], v26 offset:6272
    ds_read_b64_tr_b16 v[156:157], v26 offset:7168
    ds_read_b64_tr_b16 v[158:159], v26 offset:7296
    ds_read_b64_tr_b16 v[160:161], v26 offset:8192
    ds_read_b64_tr_b16 v[162:163], v26 offset:8320
    ds_read_b64_tr_b16 v[164:165], v26 offset:9216
    ds_read_b64_tr_b16 v[166:167], v26 offset:9344
    ds_read_b64_tr_b16 v[168:169], v26 offset:10240
    ds_read_b64_tr_b16 v[170:171], v26 offset:10368
    ds_read_b64_tr_b16 v[172:173], v26 offset:11264
    ds_read_b64_tr_b16 v[174:175], v26 offset:11392
    ds_read_b64_tr_b16 v[176:177], v26 offset:12288
    ds_read_b64_tr_b16 v[178:179], v26 offset:12416
    ds_read_b64_tr_b16 v[180:181], v26 offset:13312
    ds_read_b64_tr_b16 v[182:183], v26 offset:13440
    ds_read_b64_tr_b16 v[184:185], v26 offset:14336
    ds_read_b64_tr_b16 v[186:187], v26 offset:14464
    ds_read_b64_tr_b16 v[188:189], v26 offset:15360
    ds_read_b64_tr_b16 v[190:191], v26 offset:15488
    s_branch L_poll1w
L_poll1:
    buffer_load_dwordx4 v[4:7], v1, s[60:63], s72 offen sc1
    buffer_load_dwordx4 v[8:11], v1, s[60:63], s73 offen sc1
    buffer_load_dwordx4 v[12:15], v1, s[60:63], s74 offen sc1
    buffer_load_dwordx4 v[16:19], v1, s[60:63], s75 offen sc1
    s_add_u32 s98, s98, 1
    s_cmp_gt_u32 s98, 1048576
    s_cbranch_scc1 L_end
L_poll1w:
    s_waitcnt vmcnt(3)
    v_xor_b32 v4, s76, v4
    v_xor_b32 v5, s77, v5
    v_xor_b32 v6, s78, v6
    v_xor_b32 v7, s79, v7
    v_or3_b32 v20, v4, v5, v6
    v_or_b32 v20, v20, v7
    s_waitcnt vmcnt(2)
    v_xor_b32 v8, s76, v8
    v_xor_b32 v9, s77, v9
    v_xor_b32 v10, s78, v10
    v_xor_b32 v11, s79, v11
    v_or3_b32 v20, v20, v8, v9
    v_or3_b32 v20, v20, v10, v11
    s_waitcnt vmcnt(1)
    v_xor_b32 v12, s76, v12
    v_xor_b32 v13, s77, v13
    v_xor_b32 v14, s78, v14
    v_xor_b32 v15, s79, v15
    v_or3_b32 v20, v20, v12, v13
    v_or3_b32 v20, v20, v14, v15
    s_waitcnt vmcnt(0)
    v_xor_b32 v16, s76, v16
    v_xor_b32 v17, s77, v17
    v_xor_b32 v18, s78, v18
    v_xor_b32 v19, s79, v19
    v_or3_b32 v20, v20, v16, v17
    v_or3_b32 v20, v20, v18, v19
    v_and_b32 v20, 0xff, v20
    v_cmp_ne_u32 vcc, 0, v20
    v_pk_add_f32 v[4:5], v[4:5], v[8:9]
    v_pk_add_f32 v[6:7], v[6:7], v[10:11]
    v_pk_add_f32 v[12:13], v[12:13], v[16:17]
    v_pk_add_f32 v[14:15], v[14:15], v[18:19]
    s_and_b64 exec, exec, vcc
    s_cbranch_execnz L_poll1
    s_mov_b64 exec, -1
    v_pk_add_f32 v[4:5], v[4:5], v[12:13]
    v_pk_add_f32 v[6:7], v[6:7], v[14:15]
    v_cvt_pk_bf16_f32 v8, v4, v5
    v_cvt_pk_bf16_f32 v9, v6, v7
    v_lshlrev_b32 v4, 16, v8
    v_and_b32 v5, 0xffff0000, v8
    v_lshlrev_b32 v6, 16, v9
    v_and_b32 v7, 0xffff0000, v9
    v_pk_add_f32 v[4:5], v[4:5], v[22:23] op_sel_hi:[1,0]
    v_pk_add_f32 v[6:7], v[6:7], v[22:23] op_sel_hi:[1,0]
    v_cvt_pk_bf16_f32 v16, v4, v5
    v_cvt_pk_bf16_f32 v17, v6, v7
    v_lshlrev_b32 v4, 16, v16
    v_and_b32 v5, 0xffff0000, v16
    v_lshlrev_b32 v6, 16, v17
    v_and_b32 v7, 0xffff0000, v17
    v_lshlrev_b32 v8, 16, v16
    v_and_b32 v9, 0xffff0000, v16
    v_lshlrev_b32 v10, 16, v17
    v_and_b32 v11, 0xffff0000, v17
    v_lshlrev_b32 v12, 16, v16
    v_and_b32 v13, 0xffff0000, v16
    v_lshlrev_b32 v14, 16, v17
    v_and_b32 v15, 0xffff0000, v17
    v_permlane32_swap_b32 v4, v8
    v_permlane32_swap_b32 v5, v9
    v_permlane32_swap_b32 v6, v10
    v_permlane32_swap_b32 v7, v11
    ds_write_b128 v21, v[12:15]
    v_pk_fma_f32 v[32:33], v[32:33], v[8:9], v[4:5]
    v_pk_fma_f32 v[34:35], v[34:35], v[10:11], v[6:7]
    v_cvt_pk_bf16_f32 v32, v32, v33
    v_cvt_pk_bf16_f32 v33, v34, v35
    ds_write_b64 v3, v[32:33] offset:0
    v_pk_fma_f32 v[36:37], v[36:37], v[8:9], v[4:5]
    v_pk_fma_f32 v[38:39], v[38:39], v[10:11], v[6:7]
    v_cvt_pk_bf16_f32 v36, v36, v37
    v_cvt_pk_bf16_f32 v37, v38, v39
    ds_write_b64 v3, v[36:37] offset:1040
    v_pk_fma_f32 v[40:41], v[40:41], v[8:9], v[4:5]
    v_pk_fma_f32 v[42:43], v[42:43], v[10:11], v[6:7]
    v_cvt_pk_bf16_f32 v40, v40, v41
    v_cvt_pk_bf16_f32 v41, v42, v43
    ds_write_b64 v3, v[40:41] offset:2080
    v_pk_fma_f32 v[44:45], v[44:45], v[8:9], v[4:5]
    v_pk_fma_f32 v[46:47], v[46:47], v[10:11], v[6:7]
    v_cvt_pk_bf16_f32 v44, v44, v45
    v_cvt_pk_bf16_f32 v45, v46, v47
    ds_write_b64 v3, v[44:45] offset:3120
    s_mov_b64 exec, 1
    ds_add_u32 v24, v25
    s_mov_b64 exec, -1
    s_sub_u32 s72, s64, 1
    s_cmp_lt_u32 s72, 2
    s_cbranch_scc0 L_nokv
    s_mov_b32 s98, 0
L_lw_5:
    v_mov_b32 v4, 132140
    ds_read_b32 v4, v4
    s_add_u32 s98, s98, 1
    s_cmp_gt_u32 s98, 1048576
    s_cbranch_scc1 L_end
    s_waitcnt lgkmcnt(0)
    v_readfirstlane_b32 s79, v4
    s_nop 0
    s_cmp_ge_u32 s79, 4
    s_cbranch_scc0 L_lw_5
    ds_read_b128 v[192:195], v28 offset:0
    ds_read_b128 v[196:199], v28 offset:64
    ds_read_b128 v[200:203], v28 offset:128
    ds_read_b128 v[204:207], v28 offset:192
    ds_read_b128 v[208:211], v28 offset:256
    ds_read_b128 v[212:215], v28 offset:320
    ds_read_b128 v[216:219], v28 offset:384
    ds_read_b128 v[220:223], v28 offset:448
    ds_read_b128 v[224:227], v28 offset:512
    ds_read_b128 v[228:231], v28 offset:576
    ds_read_b128 v[232:235], v28 offset:640
    ds_read_b128 v[236:239], v28 offset:704
    ds_read_b128 v[240:243], v28 offset:768
    ds_read_b128 v[244:247], v28 offset:832
    ds_read_b128 v[248:251], v28 offset:896
    ds_read_b128 v[252:255], v28 offset:960
    s_mul_i32 s72, s65, 640
    s_add_u32 s72, s72, 65536
    s_cmp_eq_u32 s64, 2
    s_cbranch_scc1 L_vproj
    s_mov_b32 s73, 0xff00ff
    s_mov_b32 m0, 8
    s_mov_b32 s74, 0x3f803f80
    s_waitcnt lgkmcnt(14)
    v_mfma_f32_16x16x32_bf16 v[4:7], v[128:131], v[192:195], 0
    v_mfma_f32_16x16x32_bf16 v[4:7], v[132:135], v[196:199], v[4:7]
    s_waitcnt lgkmcnt(12)
    v_mfma_f32_16x16x32_bf16 v[4:7], v[136:139], v[200:203], v[4:7]
    v_mfma_f32_16x16x32_bf16 v[4:7], v[140:143], v[204:207], v[4:7]
    s_waitcnt lgkmcnt(10)
    v_mfma_f32_16x16x32_bf16 v[4:7], v[144:147], v[208:211], v[4:7]
    v_mfma_f32_16x16x32_bf16 v[4:7], v[148:151], v[212:215], v[4:7]
    s_waitcnt lgkmcnt(8)
    v_mfma_f32_16x16x32_bf16 v[4:7], v[152:155], v[216:219], v[4:7]
    v_mfma_f32_16x16x32_bf16 v[4:7], v[156:159], v[220:223], v[4:7]
    s_waitcnt lgkmcnt(6)
    v_mfma_f32_16x16x32_bf16 v[4:7], v[160:163], v[224:227], v[4:7]
    v_mfma_f32_16x16x32_bf16 v[4:7], v[164:167], v[228:231], v[4:7]
    s_waitcnt lgkmcnt(4)
    v_mfma_f32_16x16x32_bf16 v[4:7], v[168:171], v[232:235], v[4:7]
    v_mfma_f32_16x16x32_bf16 v[4:7], v[172:175], v[236:239], v[4:7]
    s_waitcnt lgkmcnt(2)
    v_mfma_f32_16x16x32_bf16 v[4:7], v[176:179], v[240:243], v[4:7]
    v_mfma_f32_16x16x32_bf16 v[4:7], v[180:183], v[244:247], v[4:7]
    s_waitcnt lgkmcnt(0)
    v_mfma_f32_16x16x32_bf16 v[4:7], v[184:187], v[248:251], v[4:7]
    v_mfma_f32_16x16x32_bf16 v[4:7], v[188:191], v[252:255], v[4:7]
    s_branch L_kvout
L_vproj:
    s_mov_b32 s73, 0x1ffff
    s_mov_b32 m0, 16
    s_mov_b32 s74, 0x3f803f80
    s_waitcnt lgkmcnt(14)
    v_mfma_f32_16x16x32_bf16 v[4:7], v[192:195], v[128:131], 0
    v_mfma_f32_16x16x32_bf16 v[4:7], v[196:199], v[132:135], v[4:7]
    s_waitcnt lgkmcnt(12)
    v_mfma_f32_16x16x32_bf16 v[4:7], v[200:203], v[136:139], v[4:7]
    v_mfma_f32_16x16x32_bf16 v[4:7], v[204:207], v[140:143], v[4:7]
    s_waitcnt lgkmcnt(10)
    v_mfma_f32_16x16x32_bf16 v[4:7], v[208:211], v[144:147], v[4:7]
    v_mfma_f32_16x16x32_bf16 v[4:7], v[212:215], v[148:151], v[4:7]
    s_waitcnt lgkmcnt(8)
    v_mfma_f32_16x16x32_bf16 v[4:7], v[216:219], v[152:155], v[4:7]
    v_mfma_f32_16x16x32_bf16 v[4:7], v[220:223], v[156:159], v[4:7]
    s_waitcnt lgkmcnt(6)
    v_mfma_f32_16x16x32_bf16 v[4:7], v[224:227], v[160:163], v[4:7]
    v_mfma_f32_16x16x32_bf16 v[4:7], v[228:231], v[164:167], v[4:7]
    s_waitcnt lgkmcnt(4)
    v_mfma_f32_16x16x32_bf16 v[4:7], v[232:235], v[168:171], v[4:7]
    v_mfma_f32_16x16x32_bf16 v[4:7], v[236:239], v[172:175], v[4:7]
    s_waitcnt lgkmcnt(2)
    v_mfma_f32_16x16x32_bf16 v[4:7], v[240:243], v[176:179], v[4:7]
    v_mfma_f32_16x16x32_bf16 v[4:7], v[244:247], v[180:183], v[4:7]
    s_waitcnt lgkmcnt(0)
    v_mfma_f32_16x16x32_bf16 v[4:7], v[248:251], v[184:187], v[4:7]
    v_mfma_f32_16x16x32_bf16 v[4:7], v[252:255], v[188:191], v[4:7]
L_kvout:
    s_nop 7
    v_cvt_pk_bf16_f32 v10, v4, v5
    v_cvt_pk_bf16_f32 v11, v6, v7
    v_cvt_pk_bf16_f32 v12, v4, v5
    v_cvt_pk_bf16_f32 v13, v6, v7
    v_cvt_pk_bf16_f32 v8, v4, v5
    v_cvt_pk_bf16_f32 v9, v6, v7
    v_permlane32_swap_b32 v12, v10
    v_permlane32_swap_b32 v13, v11
    v_min_u32 v8, -2, v8
    v_writelane_b32 v8, s74, m0
    v_writelane_b32 v9, s74, m0
    v_writelane_b32 v10, s74, m0
    v_writelane_b32 v11, s74, m0
    s_mov_b32 exec_lo, s73
    s_mov_b32 exec_hi, 0
    buffer_store_dwordx4 v[8:11], v29, s[60:63], s72 offen sc1
    s_mov_b64 exec, -1
    v_mov_b32 v4, 132140
    v_mov_b32 v5, 1
    s_mov_b64 exec, 1
    ds_add_u32 v4, v5
    s_mov_b64 exec, -1
    s_branch L_a_go
L_nokv:
    s_setprio 0
    s_cmp_eq_u32 s64, 0
    s_cbranch_scc1 L_a_xid
    s_lshr_b32 s72, s65, 5
    s_lshl_b32 s72, s72, 16
    s_bfe_u32 s73, s65, 0x10004
    s_lshl_b32 s73, s73, 13
    s_add_u32 s72, s72, s73
    s_bfe_u32 s73, s65, 0x20002
    s_lshl_b32 s73, s73, 14
    s_add_u32 s72, s72, s73
    s_lshl_b32 s73, s1, 11
    s_add_u32 s72, s72, s73
    s_add_u32 s72, s72, 524288
    buffer_store_dwordx4 v[56:59], v0, s[60:63], s72 offen sc1
    buffer_store_dwordx4 v[60:63], v0, s[60:63], s72 offen offset:1024 sc1
    s_branch L_a_go
L_a_xid:
    s_lshr_b32 s72, s65, 4
    s_lshl_b32 s72, s72, 9
    s_add_u32 s72, s72, 229376
    s_getreg_b32 s73, hwreg(HW_REG_XCC_ID)
    s_and_b32 s73, s73, 15
    v_and_b32 v6, 0xf0, v0
    v_lshlrev_b32 v6, 1, v6
    s_mov_b32 s88, s72
    s_mov_b32 s89, s73
    v_mov_b32 v16, v6
    buffer_load_dword v17, v16, s[60:63], s88 offen sc1
L_a_go:
    s_setprio 0
    v_mov_b32 v1, v30
    v_mov_b32 v3, v31
    v_add_u32 v2, 133120, v0
    s_mov_b32 s98, 0
L_lw_6:
    v_mov_b32 v8, 132140
    ds_read_b32 v8, v8
    s_add_u32 s98, s98, 1
    s_cmp_gt_u32 s98, 1048576
    s_cbranch_scc1 L_end
    s_sleep 1
    s_waitcnt lgkmcnt(0)
    v_readfirstlane_b32 s79, v8
    s_nop 0
    s_cmp_ge_u32 s79, 6
    s_cbranch_scc0 L_lw_6
    s_sleep 10
    s_mov_b32 s98, 0
L_probe:
    buffer_load_dwordx4 v[64:67], v1, s[60:63], s80 offen offset:0 sc1
    buffer_load_dwordx4 v[128:131], v3, s[60:63], s80 offen offset:0 sc1
    buffer_load_dwordx4 v[132:135], v3, s[60:63], s80 offen offset:1280 sc1
    buffer_load_dwordx4 v[68:71], v1, s[60:63], s80 offen offset:2560 sc1
    buffer_load_dwordx4 v[136:139], v3, s[60:63], s80 offen offset:2560 sc1
    buffer_load_dwordx4 v[140:143], v3, s[60:63], s80 offen offset:3840 sc1
    s_add_u32 s98, s98, 1
    s_cmp_gt_u32 s98, 1048576
    s_cbranch_scc1 L_end
    s_waitcnt vmcnt(0)
    v_max_u32 v8, v64, v68
    v_max3_u32 v8, v8, v128, v132
    v_max3_u32 v8, v8, v136, v140
    v_cmp_eq_u32 vcc, -1, v8
    s_cbranch_vccnz L_probe
    s_cmp_eq_u32 s64, 3
    s_cbranch_scc0 L_a_nfp
    s_lshl_b32 s72, s65, 5
    s_add_u32 s72, s72, 229392
    v_mov_b32 v8, s70
    s_mov_b64 exec, 1
    buffer_store_dword v8, v0, s[60:63], s72 offen sc1
    s_mov_b64 exec, -1
L_a_nfp:
    buffer_load_dwordx4 v[72:75], v1, s[60:63], s81 offen offset:0 sc1
    buffer_load_dwordx4 v[144:147], v3, s[60:63], s81 offen offset:0 sc1
    buffer_load_dwordx4 v[148:151], v3, s[60:63], s81 offen offset:1280 sc1
    buffer_load_dwordx4 v[76:79], v1, s[60:63], s81 offen offset:2560 sc1
    buffer_load_dwordx4 v[152:155], v3, s[60:63], s81 offen offset:2560 sc1
    buffer_load_dwordx4 v[156:159], v3, s[60:63], s81 offen offset:3840 sc1
    buffer_load_dwordx4 v[80:83], v1, s[60:63], s82 offen offset:0 sc1
    buffer_load_dwordx4 v[160:163], v3, s[60:63], s82 offen offset:0 sc1
    buffer_load_dwordx4 v[164:167], v3, s[60:63], s82 offen offset:1280 sc1
    buffer_load_dwordx4 v[84:87], v1, s[60:63], s82 offen offset:2560 sc1
    buffer_load_dwordx4 v[168:171], v3, s[60:63], s82 offen offset:2560 sc1
    buffer_load_dwordx4 v[172:175], v3, s[60:63], s82 offen offset:3840 sc1
    buffer_load_dwordx4 v[88:91], v1, s[60:63], s83 offen offset:0 sc1
    buffer_load_dwordx4 v[176:179], v3, s[60:63], s83 offen offset:0 sc1
    buffer_load_dwordx4 v[180:183], v3, s[60:63], s83 offen offset:1280 sc1
    buffer_load_dwordx4 v[92:95], v1, s[60:63], s83 offen offset:2560 sc1
    buffer_load_dwordx4 v[184:187], v3, s[60:63], s83 offen offset:2560 sc1
    buffer_load_dwordx4 v[188:191], v3, s[60:63], s83 offen offset:3840 sc1
    buffer_load_dwordx4 v[96:99], v1, s[60:63], s84 offen offset:0 sc1
    buffer_load_dwordx4 v[192:195], v3, s[60:63], s84 offen offset:0 sc1
    buffer_load_dwordx4 v[196:199], v3, s[60:63], s84 offen offset:1280 sc1
    buffer_load_dwordx4 v[100:103], v1, s[60:63], s84 offen offset:2560 sc1
    buffer_load_dwordx4 v[200:203], v3, s[60:63], s84 offen offset:2560 sc1
    buffer_load_dwordx4 v[204:207], v3, s[60:63], s84 offen offset:3840 sc1
    s_cmp_eq_u32 s64, 0
    s_cbranch_scc0 L_a_nx
L_xchk:
    v_xor_b32 v17, s70, v17
    v_cmp_lt_u32 vcc, 15, v17
    s_cbranch_vccnz L_pollx
    v_cmp_ne_u32 vcc, s89, v17
    s_nop 0
    s_cmp_eq_u64 vcc, 0
    s_cselect_b32 s72, 2, 1
    v_mov_b32 v17, s72
    v_mov_b32 v16, 132124
    ds_write_b32 v16, v17
L_a_nx:
    s_branch L_q0f
L_q0w:
    s_sleep 1
L_q0f:
    ds_read_b128 v[4:7], v2
    s_add_u32 s98, s98, 1
    s_cmp_gt_u32 s98, 1048576
    s_cbranch_scc1 L_end
    s_waitcnt lgkmcnt(0)
    v_cmp_eq_u32 vcc, -1, v4
    s_cbranch_vccnz L_q0w
    v_mfma_f32_32x32x16_bf16 v[32:47], v[64:67], v[4:7], 0
    v_mfma_f32_32x32x16_bf16 v[48:63], v[68:71], v[4:7], 0
    s_nop 10
    v_exp_f32 v32, v32
    v_exp_f32 v33, v33
    buffer_load_dwordx4 v[104:107], v1, s[60:63], s85 offen offset:0 sc1
    v_exp_f32 v34, v34
    v_exp_f32 v35, v35
    v_exp_f32 v36, v36
    v_cvt_pk_bf16_f32 v8, v32, v33
    v_cvt_pk_bf16_f32 v9, v34, v35
    v_exp_f32 v37, v37
    v_exp_f32 v38, v38
    v_exp_f32 v39, v39
    v_cvt_pk_bf16_f32 v10, v36, v37
    v_exp_f32 v40, v40
    v_cvt_pk_bf16_f32 v11, v38, v39
    v_exp_f32 v41, v41
    buffer_load_dwordx4 v[208:211], v3, s[60:63], s85 offen offset:0 sc1
    v_exp_f32 v42, v42
    v_mfma_f32_32x32x16_bf16 v[16:31], v[128:131], v[8:11], 0
    v_exp_f32 v43, v43
    v_cvt_pk_bf16_f32 v12, v40, v41
    v_exp_f32 v44, v44
    v_exp_f32 v45, v45
    v_cvt_pk_bf16_f32 v13, v42, v43
    v_exp_f32 v46, v46
    v_exp_f32 v47, v47
    v_cvt_pk_bf16_f32 v14, v44, v45
    v_cvt_pk_bf16_f32 v15, v46, v47
    s_waitcnt vmcnt(20)
    v_max_u32 v8, v72, v76
    v_max3_u32 v8, v8, v144, v148
    v_max3_u32 v8, v8, v152, v156
    v_cmp_eq_u32 vcc, -1, v8
    v_mfma_f32_32x32x16_bf16 v[32:47], v[72:75], v[4:7], 0
    v_exp_f32 v48, v48
    v_exp_f32 v49, v49
    buffer_load_dwordx4 v[212:215], v3, s[60:63], s85 offen offset:1280 sc1
    v_exp_f32 v50, v50
    v_exp_f32 v51, v51
    s_cbranch_vccnz L_gretry1
L_gok1:
    v_exp_f32 v52, v52
    v_cvt_pk_bf16_f32 v8, v48, v49
    v_cvt_pk_bf16_f32 v9, v50, v51
    v_exp_f32 v53, v53
    v_mfma_f32_32x32x16_bf16 v[16:31], v[132:135], v[12:15], v[16:31]
    v_exp_f32 v54, v54
    v_exp_f32 v55, v55
    v_cvt_pk_bf16_f32 v10, v52, v53
    v_exp_f32 v56, v56
    buffer_load_dwordx4 v[108:111], v1, s[60:63], s85 offen offset:2560 sc1
    v_cvt_pk_bf16_f32 v11, v54, v55
    v_exp_f32 v57, v57
    v_exp_f32 v58, v58
    v_exp_f32 v59, v59
    v_mfma_f32_32x32x16_bf16 v[16:31], v[136:139], v[8:11], v[16:31]
    v_cvt_pk_bf16_f32 v12, v56, v57
    v_exp_f32 v60, v60
    v_exp_f32 v61, v61
    v_cvt_pk_bf16_f32 v13, v58, v59
    v_exp_f32 v62, v62
    v_exp_f32 v63, v63
    v_cvt_pk_bf16_f32 v14, v60, v61
    v_cvt_pk_bf16_f32 v15, v62, v63
    v_mfma_f32_32x32x16_bf16 v[48:63], v[76:79], v[4:7], 0
    v_exp_f32 v32, v32
    v_exp_f32 v33, v33
    buffer_load_dwordx4 v[216:219], v3, s[60:63], s85 offen offset:2560 sc1
    v_exp_f32 v34, v34
    v_exp_f32 v35, v35
    v_exp_f32 v36, v36
    v_cvt_pk_bf16_f32 v8, v32, v33
    v_cvt_pk_bf16_f32 v9, v34, v35
    v_exp_f32 v37, v37
    v_mfma_f32_32x32x16_bf16 v[16:31], v[140:143], v[12:15], v[16:31]
    v_exp_f32 v38, v38
    v_exp_f32 v39, v39
    v_cvt_pk_bf16_f32 v10, v36, v37
    v_exp_f32 v40, v40
    v_cvt_pk_bf16_f32 v11, v38, v39
    buffer_load_dwordx4 v[220:223], v3, s[60:63], s85 offen offset:3840 sc1
    v_exp_f32 v41, v41
    v_exp_f32 v42, v42
    v_exp_f32 v43, v43
    v_mfma_f32_32x32x16_bf16 v[16:31], v[144:147], v[8:11], v[16:31]
    v_cvt_pk_bf16_f32 v12, v40, v41
    v_exp_f32 v44, v44
    v_exp_f32 v45, v45
    v_cvt_pk_bf16_f32 v13, v42, v43
    v_exp_f32 v46, v46
    v_exp_f32 v47, v47
    v_cvt_pk_bf16_f32 v14, v44, v45
    v_cvt_pk_bf16_f32 v15, v46, v47
    s_waitcnt vmcnt(18)
    v_max_u32 v8, v80, v84
    v_max3_u32 v8, v8, v160, v164
    v_max3_u32 v8, v8, v168, v172
    v_cmp_eq_u32 vcc, -1, v8
    v_mfma_f32_32x32x16_bf16 v[32:47], v[80:83], v[4:7], 0
    v_exp_f32 v48, v48
    v_exp_f32 v49, v49
    buffer_load_dwordx4 v[112:115], v1, s[60:63], s86 offen offset:0 sc1
    v_exp_f32 v50, v50
    v_exp_f32 v51, v51
    s_cbranch_vccnz L_gretry2
L_gok2:
    v_exp_f32 v52, v52
    v_cvt_pk_bf16_f32 v8, v48, v49
    v_cvt_pk_bf16_f32 v9, v50, v51
    v_exp_f32 v53, v53
    v_mfma_f32_32x32x16_bf16 v[16:31], v[148:151], v[12:15], v[16:31]
    v_exp_f32 v54, v54
    v_exp_f32 v55, v55
    v_cvt_pk_bf16_f32 v10, v52, v53
    v_exp_f32 v56, v56
    buffer_load_dwordx4 v[224:227], v3, s[60:63], s86 offen offset:0 sc1
    v_cvt_pk_bf16_f32 v11, v54, v55
    v_exp_f32 v57, v57
    v_exp_f32 v58, v58
    v_exp_f32 v59, v59
    v_mfma_f32_32x32x16_bf16 v[16:31], v[152:155], v[8:11], v[16:31]
    v_cvt_pk_bf16_f32 v12, v56, v57
    v_exp_f32 v60, v60
    v_exp_f32 v61, v61
    v_cvt_pk_bf16_f32 v13, v58, v59
    v_exp_f32 v62, v62
    v_exp_f32 v63, v63
    v_cvt_pk_bf16_f32 v14, v60, v61
    v_cvt_pk_bf16_f32 v15, v62, v63
    v_mfma_f32_32x32x16_bf16 v[48:63], v[84:87], v[4:7], 0
    v_exp_f32 v32, v32
    v_exp_f32 v33, v33
    buffer_load_dwordx4 v[228:231], v3, s[60:63], s86 offen offset:1280 sc1
    v_exp_f32 v34, v34
    v_exp_f32 v35, v35
    v_exp_f32 v36, v36
    v_cvt_pk_bf16_f32 v8, v32, v33
    v_cvt_pk_bf16_f32 v9, v34, v35
    v_exp_f32 v37, v37
    v_mfma_f32_32x32x16_bf16 v[16:31], v[156:159], v[12:15], v[16:31]
    v_exp_f32 v38, v38
    v_exp_f32 v39, v39
    v_cvt_pk_bf16_f32 v10, v36, v37
    v_exp_f32 v40, v40
    v_cvt_pk_bf16_f32 v11, v38, v39
    buffer_load_dwordx4 v[116:119], v1, s[60:63], s86 offen offset:2560 sc1
    v_exp_f32 v41, v41
    v_exp_f32 v42, v42
    v_exp_f32 v43, v43
    v_mfma_f32_32x32x16_bf16 v[16:31], v[160:163], v[8:11], v[16:31]
    v_cvt_pk_bf16_f32 v12, v40, v41
    v_exp_f32 v44, v44
    v_exp_f32 v45, v45
    v_cvt_pk_bf16_f32 v13, v42, v43
    v_exp_f32 v46, v46
    v_exp_f32 v47, v47
    v_cvt_pk_bf16_f32 v14, v44, v45
    v_cvt_pk_bf16_f32 v15, v46, v47
    s_waitcnt vmcnt(16)
    v_max_u32 v8, v88, v92
    v_max3_u32 v8, v8, v176, v180
    v_max3_u32 v8, v8, v184, v188
    v_cmp_eq_u32 vcc, -1, v8
    v_mfma_f32_32x32x16_bf16 v[32:47], v[88:91], v[4:7], 0
    v_exp_f32 v48, v48
    v_exp_f32 v49, v49
    buffer_load_dwordx4 v[232:235], v3, s[60:63], s86 offen offset:2560 sc1
    v_exp_f32 v50, v50
    v_exp_f32 v51, v51
    s_cbranch_vccnz L_gretry3
L_gok3:
    v_exp_f32 v52, v52
    v_cvt_pk_bf16_f32 v8, v48, v49
    v_cvt_pk_bf16_f32 v9, v50, v51
    v_exp_f32 v53, v53
    v_mfma_f32_32x32x16_bf16 v[16:31], v[164:167], v[12:15], v[16:31]
    v_exp_f32 v54, v54
    v_exp_f32 v55, v55
    v_cvt_pk_bf16_f32 v10, v52, v53
    v_exp_f32 v56, v56
    buffer_load_dwordx4 v[236:239], v3, s[60:63], s86 offen offset:3840 sc1
    v_cvt_pk_bf16_f32 v11, v54, v55
    v_exp_f32 v57, v57
    v_exp_f32 v58, v58
    v_exp_f32 v59, v59
    v_mfma_f32_32x32x16_bf16 v[16:31], v[168:171], v[8:11], v[16:31]
    v_cvt_pk_bf16_f32 v12, v56, v57
    v_exp_f32 v60, v60
    v_exp_f32 v61, v61
    v_cvt_pk_bf16_f32 v13, v58, v59
    v_exp_f32 v62, v62
    v_exp_f32 v63, v63
    v_cvt_pk_bf16_f32 v14, v60, v61
    v_cvt_pk_bf16_f32 v15, v62, v63
    v_mfma_f32_32x32x16_bf16 v[48:63], v[92:95], v[4:7], 0
    v_exp_f32 v32, v32
    v_exp_f32 v33, v33
    buffer_load_dwordx4 v[120:123], v1, s[60:63], s87 offen offset:0 sc1
    v_exp_f32 v34, v34
    v_exp_f32 v35, v35
    v_exp_f32 v36, v36
    v_cvt_pk_bf16_f32 v8, v32, v33
    v_cvt_pk_bf16_f32 v9, v34, v35
    v_exp_f32 v37, v37
    v_mfma_f32_32x32x16_bf16 v[16:31], v[172:175], v[12:15], v[16:31]
    v_exp_f32 v38, v38
    v_exp_f32 v39, v39
    v_cvt_pk_bf16_f32 v10, v36, v37
    v_exp_f32 v40, v40
    v_cvt_pk_bf16_f32 v11, v38, v39
    buffer_load_dwordx4 v[240:243], v3, s[60:63], s87 offen offset:0 sc1
    v_exp_f32 v41, v41
    v_exp_f32 v42, v42
    v_exp_f32 v43, v43
    v_mfma_f32_32x32x16_bf16 v[16:31], v[176:179], v[8:11], v[16:31]
    v_cvt_pk_bf16_f32 v12, v40, v41
    v_exp_f32 v44, v44
    v_exp_f32 v45, v45
    v_cvt_pk_bf16_f32 v13, v42, v43
    v_exp_f32 v46, v46
    v_exp_f32 v47, v47
    v_cvt_pk_bf16_f32 v14, v44, v45
    v_cvt_pk_bf16_f32 v15, v46, v47
    s_waitcnt vmcnt(14)
    v_max_u32 v8, v96, v100
    v_max3_u32 v8, v8, v192, v196
    v_max3_u32 v8, v8, v200, v204
    v_cmp_eq_u32 vcc, -1, v8
    v_mfma_f32_32x32x16_bf16 v[32:47], v[96:99], v[4:7], 0
    v_exp_f32 v48, v48
    v_exp_f32 v49, v49
    buffer_load_dwordx4 v[244:247], v3, s[60:63], s87 offen offset:1280 sc1
    v_exp_f32 v50, v50
    v_exp_f32 v51, v51
    s_cbranch_vccnz L_gretry4
L_gok4:
    v_exp_f32 v52, v52
    v_cvt_pk_bf16_f32 v8, v48, v49
    v_cvt_pk_bf16_f32 v9, v50, v51
    v_exp_f32 v53, v53
    v_mfma_f32_32x32x16_bf16 v[16:31], v[180:183], v[12:15], v[16:31]
    v_exp_f32 v54, v54
    v_exp_f32 v55, v55
    v_cvt_pk_bf16_f32 v10, v52, v53
    v_exp_f32 v56, v56
    buffer_load_dwordx4 v[124:127], v1, s[60:63], s87 offen offset:2560 sc1
    v_cvt_pk_bf16_f32 v11, v54, v55
    v_exp_f32 v57, v57
    v_exp_f32 v58, v58
    v_exp_f32 v59, v59
    v_mfma_f32_32x32x16_bf16 v[16:31], v[184:187], v[8:11], v[16:31]
    v_cvt_pk_bf16_f32 v12, v56, v57
    v_exp_f32 v60, v60
    v_exp_f32 v61, v61
    v_cvt_pk_bf16_f32 v13, v58, v59
    v_exp_f32 v62, v62
    v_exp_f32 v63, v63
    v_cvt_pk_bf16_f32 v14, v60, v61
    v_cvt_pk_bf16_f32 v15, v62, v63
    v_mfma_f32_32x32x16_bf16 v[48:63], v[100:103], v[4:7], 0
    v_exp_f32 v32, v32
    v_exp_f32 v33, v33
    buffer_load_dwordx4 v[248:251], v3, s[60:63], s87 offen offset:2560 sc1
    v_exp_f32 v34, v34
    v_exp_f32 v35, v35
    v_exp_f32 v36, v36
    v_cvt_pk_bf16_f32 v8, v32, v33
    v_cvt_pk_bf16_f32 v9, v34, v35
    v_exp_f32 v37, v37
    v_mfma_f32_32x32x16_bf16 v[16:31], v[188:191], v[12:15], v[16:31]
    v_exp_f32 v38, v38
    v_exp_f32 v39, v39
    v_cvt_pk_bf16_f32 v10, v36, v37
    v_exp_f32 v40, v40
    v_cvt_pk_bf16_f32 v11, v38, v39
    buffer_load_dwordx4 v[252:255], v3, s[60:63], s87 offen offset:3840 sc1
    v_exp_f32 v41, v41
    v_exp_f32 v42, v42
    v_exp_f32 v43, v43
    v_mfma_f32_32x32x16_bf16 v[16:31], v[192:195], v[8:11], v[16:31]
    v_cvt_pk_bf16_f32 v12, v40, v41
    v_exp_f32 v44, v44
    v_exp_f32 v45, v45
    v_cvt_pk_bf16_f32 v13, v42, v43
    v_exp_f32 v46, v46
    v_exp_f32 v47, v47
    v_cvt_pk_bf16_f32 v14, v44, v45
    v_cvt_pk_bf16_f32 v15, v46, v47
    s_waitcnt vmcnt(12)
    v_max_u32 v8, v104, v108
    v_max3_u32 v8, v8, v208, v212
    v_max3_u32 v8, v8, v216, v220
    v_cmp_eq_u32 vcc, -1, v8
    v_mfma_f32_32x32x16_bf16 v[32:47], v[104:107], v[4:7], 0
    v_exp_f32 v48, v48
    v_exp_f32 v49, v49
    v_exp_f32 v50, v50
    v_exp_f32 v51, v51
    s_cbranch_vccnz L_gretry5
L_gok5:
    v_exp_f32 v52, v52
    v_cvt_pk_bf16_f32 v8, v48, v49
    v_cvt_pk_bf16_f32 v9, v50, v51
    v_exp_f32 v53, v53
    v_mfma_f32_32x32x16_bf16 v[16:31], v[196:199], v[12:15], v[16:31]
    v_exp_f32 v54, v54
    v_exp_f32 v55, v55
    v_cvt_pk_bf16_f32 v10, v52, v53
    v_exp_f32 v56, v56
    v_cvt_pk_bf16_f32 v11, v54, v55
    v_exp_f32 v57, v57
    v_exp_f32 v58, v58
    v_exp_f32 v59, v59
    v_mfma_f32_32x32x16_bf16 v[16:31], v[200:203], v[8:11], v[16:31]
    v_cvt_pk_bf16_f32 v12, v56, v57
    v_exp_f32 v60, v60
    v_exp_f32 v61, v61
    v_cvt_pk_bf16_f32 v13, v58, v59
    v_exp_f32 v62, v62
    v_exp_f32 v63, v63
    v_cvt_pk_bf16_f32 v14, v60, v61
    v_cvt_pk_bf16_f32 v15, v62, v63
    v_mov_b32 v8, 132112
    v_mov_b32 v9, 1
    s_mov_b64 exec, 1
    ds_add_u32 v8, v9
    s_mov_b64 exec, -1
    v_mfma_f32_32x32x16_bf16 v[48:63], v[108:111], v[4:7], 0
    v_exp_f32 v32, v32
    v_exp_f32 v33, v33
    v_exp_f32 v34, v34
    v_exp_f32 v35, v35
    v_exp_f32 v36, v36
    v_cvt_pk_bf16_f32 v8, v32, v33
    v_cvt_pk_bf16_f32 v9, v34, v35
    v_exp_f32 v37, v37
    v_mfma_f32_32x32x16_bf16 v[16:31], v[204:207], v[12:15], v[16:31]
    v_exp_f32 v38, v38
    v_exp_f32 v39, v39
    v_cvt_pk_bf16_f32 v10, v36, v37
    v_exp_f32 v40, v40
    v_cvt_pk_bf16_f32 v11, v38, v39
    v_exp_f32 v41, v41
    v_exp_f32 v42, v42
    v_exp_f32 v43, v43
    v_mfma_f32_32x32x16_bf16 v[16:31], v[208:211], v[8:11], v[16:31]
    v_cvt_pk_bf16_f32 v12, v40, v41
    v_exp_f32 v44, v44
    v_exp_f32 v45, v45
    v_cvt_pk_bf16_f32 v13, v42, v43
    v_exp_f32 v46, v46
    v_exp_f32 v47, v47
    v_cvt_pk_bf16_f32 v14, v44, v45
    v_cvt_pk_bf16_f32 v15, v46, v47
    s_waitcnt vmcnt(6)
    v_max_u32 v8, v112, v116
    v_max3_u32 v8, v8, v224, v228
    v_max3_u32 v8, v8, v232, v236
    v_cmp_eq_u32 vcc, -1, v8
    v_mfma_f32_32x32x16_bf16 v[32:47], v[112:115], v[4:7], 0
    v_exp_f32 v48, v48
    v_exp_f32 v49, v49
    v_exp_f32 v50, v50
    v_exp_f32 v51, v51
    s_cbranch_vccnz L_gretry6
L_gok6:
    v_exp_f32 v52, v52
    v_cvt_pk_bf16_f32 v8, v48, v49
    v_cvt_pk_bf16_f32 v9, v50, v51
    v_exp_f32 v53, v53
    v_mfma_f32_32x32x16_bf16 v[16:31], v[212:215], v[12:15], v[16:31]
    v_exp_f32 v54, v54
    v_exp_f32 v55, v55
    v_cvt_pk_bf16_f32 v10, v52, v53
    v_exp_f32 v56, v56
    v_cvt_pk_bf16_f32 v11, v54, v55
    v_exp_f32 v57, v57
    v_exp_f32 v58, v58
    v_exp_f32 v59, v59
    v_mfma_f32_32x32x16_bf16 v[16:31], v[216:219], v[8:11], v[16:31]
    v_cvt_pk_bf16_f32 v12, v56, v57
    v_exp_f32 v60, v60
    v_exp_f32 v61, v61
    v_cvt_pk_bf16_f32 v13, v58, v59
    v_exp_f32 v62, v62
    v_exp_f32 v63, v63
    v_cvt_pk_bf16_f32 v14, v60, v61
    v_cvt_pk_bf16_f32 v15, v62, v63
    v_mfma_f32_32x32x16_bf16 v[48:63], v[116:119], v[4:7], 0
    v_exp_f32 v32, v32
    v_exp_f32 v33, v33
    v_exp_f32 v34, v34
    v_exp_f32 v35, v35
    v_exp_f32 v36, v36
    v_cvt_pk_bf16_f32 v8, v32, v33
    v_cvt_pk_bf16_f32 v9, v34, v35
    v_exp_f32 v37, v37
    v_mfma_f32_32x32x16_bf16 v[16:31], v[220:223], v[12:15], v[16:31]
    v_exp_f32 v38, v38
    v_exp_f32 v39, v39
    v_cvt_pk_bf16_f32 v10, v36, v37
    v_exp_f32 v40, v40
    v_cvt_pk_bf16_f32 v11, v38, v39
    v_exp_f32 v41, v41
    v_exp_f32 v42, v42
    v_exp_f32 v43, v43
    v_mfma_f32_32x32x16_bf16 v[16:31], v[224:227], v[8:11], v[16:31]
    v_cvt_pk_bf16_f32 v12, v40, v41
    v_exp_f32 v44, v44
    v_exp_f32 v45, v45
    v_cvt_pk_bf16_f32 v13, v42, v43
    v_exp_f32 v46, v46
    v_exp_f32 v47, v47
    v_cvt_pk_bf16_f32 v14, v44, v45
    v_cvt_pk_bf16_f32 v15, v46, v47
    s_waitcnt vmcnt(0)
    v_max_u32 v8, v120, v124
    v_max3_u32 v8, v8, v240, v244
    v_max3_u32 v8, v8, v248, v252
    v_cmp_eq_u32 vcc, -1, v8
    v_mfma_f32_32x32x16_bf16 v[32:47], v[120:123], v[4:7], 0
    v_exp_f32 v48, v48
    v_exp_f32 v49, v49
    v_exp_f32 v50, v50
    v_exp_f32 v51, v51
    s_cbranch_vccnz L_gretry7
L_gok7:
    v_exp_f32 v52, v52
    v_cvt_pk_bf16_f32 v8, v48, v49
    v_cvt_pk_bf16_f32 v9, v50, v51
    v_exp_f32 v53, v53
    v_mfma_f32_32x32x16_bf16 v[16:31], v[228:231], v[12:15], v[16:31]
    v_exp_f32 v54, v54
    v_exp_f32 v55, v55
    v_cvt_pk_bf16_f32 v10, v52, v53
    v_exp_f32 v56, v56
    v_cvt_pk_bf16_f32 v11, v54, v55
    v_exp_f32 v57, v57
    v_exp_f32 v58, v58
    v_exp_f32 v59, v59
    v_mfma_f32_32x32x16_bf16 v[16:31], v[232:235], v[8:11], v[16:31]
    v_cvt_pk_bf16_f32 v12, v56, v57
    v_exp_f32 v60, v60
    v_exp_f32 v61, v61
    v_cvt_pk_bf16_f32 v13, v58, v59
    v_exp_f32 v62, v62
    v_exp_f32 v63, v63
    v_cvt_pk_bf16_f32 v14, v60, v61
    v_cvt_pk_bf16_f32 v15, v62, v63
    v_mfma_f32_32x32x16_bf16 v[48:63], v[124:127], v[4:7], 0
    v_add_u32 v2, 1024, v2
    ds_read_b128 v[4:7], v2
    v_exp_f32 v32, v32
    v_exp_f32 v33, v33
    v_exp_f32 v34, v34
    v_exp_f32 v35, v35
    v_exp_f32 v36, v36
    v_cvt_pk_bf16_f32 v8, v32, v33
    v_cvt_pk_bf16_f32 v9, v34, v35
    v_exp_f32 v37, v37
    v_mfma_f32_32x32x16_bf16 v[16:31], v[236:239], v[12:15], v[16:31]
    v_exp_f32 v38, v38
    v_exp_f32 v39, v39
    v_cvt_pk_bf16_f32 v10, v36, v37
    v_exp_f32 v40, v40
    v_cvt_pk_bf16_f32 v11, v38, v39
    v_exp_f32 v41, v41
    v_exp_f32 v42, v42
    v_exp_f32 v43, v43
    v_mfma_f32_32x32x16_bf16 v[16:31], v[240:243], v[8:11], v[16:31]
    v_cvt_pk_bf16_f32 v12, v40, v41
    v_exp_f32 v44, v44
    v_exp_f32 v45, v45
    v_cvt_pk_bf16_f32 v13, v42, v43
    v_exp_f32 v46, v46
    v_exp_f32 v47, v47
    v_cvt_pk_bf16_f32 v14, v44, v45
    v_cvt_pk_bf16_f32 v15, v46, v47
    s_waitcnt lgkmcnt(0)
    v_cmp_eq_u32 vcc, -1, v4
    s_cbranch_vccnz L_qwaita
L_qoka:
    v_mfma_f32_32x32x16_bf16 v[32:47], v[64:67], v[4:7], 0
    v_exp_f32 v48, v48
    v_exp_f32 v49, v49
    v_exp_f32 v50, v50
    v_exp_f32 v51, v51
    v_exp_f32 v52, v52
    v_cvt_pk_bf16_f32 v8, v48, v49
    v_cvt_pk_bf16_f32 v9, v50, v51
    v_exp_f32 v53, v53
    v_mfma_f32_32x32x16_bf16 v[16:31], v[244:247], v[12:15], v[16:31]
    v_exp_f32 v54, v54
    v_exp_f32 v55, v55
    v_cvt_pk_bf16_f32 v10, v52, v53
    v_exp_f32 v56, v56
    v_cvt_pk_bf16_f32 v11, v54, v55
    v_exp_f32 v57, v57
    v_exp_f32 v58, v58
    v_exp_f32 v59, v59
    v_mfma_f32_32x32x16_bf16 v[16:31], v[248:251], v[8:11], v[16:31]
    v_cvt_pk_bf16_f32 v12, v56, v57
    v_exp_f32 v60, v60
    v_exp_f32 v61, v61
    v_cvt_pk_bf16_f32 v13, v58, v59
    v_exp_f32 v62, v62
    v_exp_f32 v63, v63
    v_cvt_pk_bf16_f32 v14, v60, v61
    v_cvt_pk_bf16_f32 v15, v62, v63
    s_lshl_b32 s72, s64, 11
    s_add_u32 s72, s72, 141312
    v_add_u32 v3, s72, v0
    s_lshl_b32 s72, s64, 7
    s_add_u32 s72, s72, 149504
    v_bfe_u32 v1, v0, 2, 7
    v_add_u32 v1, s72, v1
    s_mov_b32 s99, 1
.p2align 6
L_attn:
    v_mfma_f32_32x32x16_bf16 v[48:63], v[68:71], v[4:7], 0
    v_exp_f32 v32, v32
    v_exp_f32 v33, v33
    v_exp_f32 v34, v34
    v_mfma_f32_32x32x16_bf16 v[16:31], v[252:255], v[12:15], v[16:31]
    v_exp_f32 v35, v35
    v_exp_f32 v36, v36
    v_cvt_pk_bf16_f32 v8, v32, v33
    v_cvt_pk_bf16_f32 v9, v34, v35
    v_exp_f32 v37, v37
    v_exp_f32 v38, v38
    v_exp_f32 v39, v39
    v_cvt_pk_bf16_f32 v10, v36, v37
    v_exp_f32 v40, v40
    v_cvt_pk_bf16_f32 v11, v38, v39
    v_exp_f32 v41, v41
    v_exp_f32 v42, v42
    ds_write_b128 v3, v[16:19]
    ds_write_b128 v3, v[20:23] offset:1024
    ds_write_b32 v1, v24
    v_mfma_f32_32x32x16_bf16 v[16:31], v[128:131], v[8:11], 0
    v_exp_f32 v43, v43
    v_cvt_pk_bf16_f32 v12, v40, v41
    v_exp_f32 v44, v44
    v_exp_f32 v45, v45
    v_cvt_pk_bf16_f32 v13, v42, v43
    v_exp_f32 v46, v46
    v_exp_f32 v47, v47
    v_cvt_pk_bf16_f32 v14, v44, v45
    v_cvt_pk_bf16_f32 v15, v46, v47
    v_mfma_f32_32x32x16_bf16 v[32:47], v[72:75], v[4:7], 0
    v_exp_f32 v48, v48
    v_exp_f32 v49, v49
    v_exp_f32 v50, v50
    v_exp_f32 v51, v51
    v_exp_f32 v52, v52
    v_cvt_pk_bf16_f32 v8, v48, v49
    v_cvt_pk_bf16_f32 v9, v50, v51
    v_exp_f32 v53, v53
    v_mfma_f32_32x32x16_bf16 v[16:31], v[132:135], v[12:15], v[16:31]
    v_exp_f32 v54, v54
    v_exp_f32 v55, v55
    v_cvt_pk_bf16_f32 v10, v52, v53
    v_exp_f32 v56, v56
    v_cvt_pk_bf16_f32 v11, v54, v55
    v_exp_f32 v57, v57
    v_exp_f32 v58, v58
    v_exp_f32 v59, v59
    v_mfma_f32_32x32x16_bf16 v[16:31], v[136:139], v[8:11], v[16:31]
    v_cvt_pk_bf16_f32 v12, v56, v57
    v_exp_f32 v60, v60
    v_exp_f32 v61, v61
    v_cvt_pk_bf16_f32 v13, v58, v59
    v_exp_f32 v62, v62
    v_exp_f32 v63, v63
    v_cvt_pk_bf16_f32 v14, v60, v61
    v_cvt_pk_bf16_f32 v15, v62, v63
    v_mfma_f32_32x32x16_bf16 v[48:63], v[76:79], v[4:7], 0
    v_exp_f32 v32, v32
    v_exp_f32 v33, v33
    v_exp_f32 v34, v34
    v_exp_f32 v35, v35
    v_exp_f32 v36, v36
    v_cvt_pk_bf16_f32 v8, v32, v33
    v_cvt_pk_bf16_f32 v9, v34, v35
    v_exp_f32 v37, v37
    v_mfma_f32_32x32x16_bf16 v[16:31], v[140:143], v[12:15], v[16:31]
    v_exp_f32 v38, v38
    v_exp_f32 v39, v39
    v_cvt_pk_bf16_f32 v10, v36, v37
    v_exp_f32 v40, v40
    v_cvt_pk_bf16_f32 v11, v38, v39
    v_exp_f32 v41, v41
    v_exp_f32 v42, v42
    v_exp_f32 v43, v43
    v_mfma_f32_32x32x16_bf16 v[16:31], v[144:147], v[8:11], v[16:31]
    v_cvt_pk_bf16_f32 v12, v40, v41
    v_exp_f32 v44, v44
    v_exp_f32 v45, v45
    v_cvt_pk_bf16_f32 v13, v42, v43
    v_exp_f32 v46, v46
    v_exp_f32 v47, v47
    v_cvt_pk_bf16_f32 v14, v44, v45
    v_cvt_pk_bf16_f32 v15, v46, v47
    v_mfma_f32_32x32x16_bf16 v[32:47], v[80:83], v[4:7], 0
    v_exp_f32 v48, v48
    v_exp_f32 v49, v49
    v_exp_f32 v50, v50
    v_exp_f32 v51, v51
    v_exp_f32 v52, v52
    v_cvt_pk_bf16_f32 v8, v48, v49
    v_cvt_pk_bf16_f32 v9, v50, v51
    v_exp_f32 v53, v53
    v_mfma_f32_32x32x16_bf16 v[16:31], v[148:151], v[12:15], v[16:31]
    v_exp_f32 v54, v54
    v_exp_f32 v55, v55
    v_cvt_pk_bf16_f32 v10, v52, v53
    v_exp_f32 v56, v56
    v_cvt_pk_bf16_f32 v11, v54, v55
    v_exp_f32 v57, v57
    v_exp_f32 v58, v58
    v_exp_f32 v59, v59
    v_mfma_f32_32x32x16_bf16 v[16:31], v[152:155], v[8:11], v[16:31]
    v_cvt_pk_bf16_f32 v12, v56, v57
    v_exp_f32 v60, v60
    v_exp_f32 v61, v61
    v_cvt_pk_bf16_f32 v13, v58, v59
    v_exp_f32 v62, v62
    v_exp_f32 v63, v63
    v_cvt_pk_bf16_f32 v14, v60, v61
    v_cvt_pk_bf16_f32 v15, v62, v63
    v_mfma_f32_32x32x16_bf16 v[48:63], v[84:87], v[4:7], 0
    v_exp_f32 v32, v32
    v_exp_f32 v33, v33
    v_exp_f32 v34, v34
    v_exp_f32 v35, v35
    v_exp_f32 v36, v36
    v_cvt_pk_bf16_f32 v8, v32, v33
    v_cvt_pk_bf16_f32 v9, v34, v35
    v_exp_f32 v37, v37
    v_mfma_f32_32x32x16_bf16 v[16:31], v[156:159], v[12:15], v[16:31]
    v_exp_f32 v38, v38
    v_exp_f32 v39, v39
    v_cvt_pk_bf16_f32 v10, v36, v37
    v_exp_f32 v40, v40
    v_cvt_pk_bf16_f32 v11, v38, v39
    v_exp_f32 v41, v41
    v_exp_f32 v42, v42
    v_exp_f32 v43, v43
    v_mfma_f32_32x32x16_bf16 v[16:31], v[160:163], v[8:11], v[16:31]
    v_cvt_pk_bf16_f32 v12, v40, v41
    v_exp_f32 v44, v44
    v_exp_f32 v45, v45
    v_cvt_pk_bf16_f32 v13, v42, v43
    v_exp_f32 v46, v46
    v_exp_f32 v47, v47
    v_cvt_pk_bf16_f32 v14, v44, v45
    v_cvt_pk_bf16_f32 v15, v46, v47
    v_mfma_f32_32x32x16_bf16 v[32:47], v[88:91], v[4:7], 0
    v_exp_f32 v48, v48
    v_exp_f32 v49, v49
    v_exp_f32 v50, v50
    v_exp_f32 v51, v51
    v_exp_f32 v52, v52
    v_cvt_pk_bf16_f32 v8, v48, v49
    v_cvt_pk_bf16_f32 v9, v50, v51
    v_exp_f32 v53, v53
    v_mfma_f32_32x32x16_bf16 v[16:31], v[164:167], v[12:15], v[16:31]
    v_exp_f32 v54, v54
    v_exp_f32 v55, v55
    v_cvt_pk_bf16_f32 v10, v52, v53
    v_exp_f32 v56, v56
    v_cvt_pk_bf16_f32 v11, v54, v55
    v_exp_f32 v57, v57
    v_exp_f32 v58, v58
    v_exp_f32 v59, v59
    v_mfma_f32_32x32x16_bf16 v[16:31], v[168:171], v[8:11], v[16:31]
    v_cvt_pk_bf16_f32 v12, v56, v57
    v_exp_f32 v60, v60
    v_exp_f32 v61, v61
    v_cvt_pk_bf16_f32 v13, v58, v59
    v_exp_f32 v62, v62
    v_exp_f32 v63, v63
    v_cvt_pk_bf16_f32 v14, v60, v61
    v_cvt_pk_bf16_f32 v15, v62, v63
    v_mfma_f32_32x32x16_bf16 v[48:63], v[92:95], v[4:7], 0
    v_exp_f32 v32, v32
    v_exp_f32 v33, v33
    v_exp_f32 v34, v34
    v_exp_f32 v35, v35
    v_exp_f32 v36, v36
    v_cvt_pk_bf16_f32 v8, v32, v33
    v_cvt_pk_bf16_f32 v9, v34, v35
    v_exp_f32 v37, v37
    v_mfma_f32_32x32x16_bf16 v[16:31], v[172:175], v[12:15], v[16:31]
    v_exp_f32 v38, v38
    v_exp_f32 v39, v39
    v_cvt_pk_bf16_f32 v10, v36, v37
    v_exp_f32 v40, v40
    v_cvt_pk_bf16_f32 v11, v38, v39
    v_exp_f32 v41, v41
    v_exp_f32 v42, v42
    v_exp_f32 v43, v43
    v_mfma_f32_32x32x16_bf16 v[16:31], v[176:179], v[8:11], v[16:31]
    v_cvt_pk_bf16_f32 v12, v40, v41
    v_exp_f32 v44, v44
    v_exp_f32 v45, v45
    v_cvt_pk_bf16_f32 v13, v42, v43
    v_exp_f32 v46, v46
    v_exp_f32 v47, v47
    v_cvt_pk_bf16_f32 v14, v44, v45
    v_cvt_pk_bf16_f32 v15, v46, v47
    v_mfma_f32_32x32x16_bf16 v[32:47], v[96:99], v[4:7], 0
    v_exp_f32 v48, v48
    v_exp_f32 v49, v49
    v_exp_f32 v50, v50
    v_exp_f32 v51, v51
    v_exp_f32 v52, v52
    v_cvt_pk_bf16_f32 v8, v48, v49
    v_cvt_pk_bf16_f32 v9, v50, v51
    v_exp_f32 v53, v53
    v_mfma_f32_32x32x16_bf16 v[16:31], v[180:183], v[12:15], v[16:31]
    v_exp_f32 v54, v54
    v_exp_f32 v55, v55
    v_cvt_pk_bf16_f32 v10, v52, v53
    v_exp_f32 v56, v56
    v_cvt_pk_bf16_f32 v11, v54, v55
    v_exp_f32 v57, v57
    v_exp_f32 v58, v58
    v_exp_f32 v59, v59
    v_mfma_f32_32x32x16_bf16 v[16:31], v[184:187], v[8:11], v[16:31]
    v_cvt_pk_bf16_f32 v12, v56, v57
    v_exp_f32 v60, v60
    v_exp_f32 v61, v61
    v_cvt_pk_bf16_f32 v13, v58, v59
    v_exp_f32 v62, v62
    v_exp_f32 v63, v63
    v_cvt_pk_bf16_f32 v14, v60, v61
    v_cvt_pk_bf16_f32 v15, v62, v63
    v_mfma_f32_32x32x16_bf16 v[48:63], v[100:103], v[4:7], 0
    v_exp_f32 v32, v32
    v_exp_f32 v33, v33
    v_exp_f32 v34, v34
    v_exp_f32 v35, v35
    v_exp_f32 v36, v36
    v_cvt_pk_bf16_f32 v8, v32, v33
    v_cvt_pk_bf16_f32 v9, v34, v35
    v_exp_f32 v37, v37
    v_mfma_f32_32x32x16_bf16 v[16:31], v[188:191], v[12:15], v[16:31]
    v_exp_f32 v38, v38
    v_exp_f32 v39, v39
    v_cvt_pk_bf16_f32 v10, v36, v37
    v_exp_f32 v40, v40
    v_cvt_pk_bf16_f32 v11, v38, v39
    v_exp_f32 v41, v41
    v_exp_f32 v42, v42
    v_exp_f32 v43, v43
    v_mfma_f32_32x32x16_bf16 v[16:31], v[192:195], v[8:11], v[16:31]
    v_cvt_pk_bf16_f32 v12, v40, v41
    v_exp_f32 v44, v44
    v_exp_f32 v45, v45
    v_cvt_pk_bf16_f32 v13, v42, v43
    v_exp_f32 v46, v46
    v_exp_f32 v47, v47
    v_cvt_pk_bf16_f32 v14, v44, v45
    v_cvt_pk_bf16_f32 v15, v46, v47
    v_mfma_f32_32x32x16_bf16 v[32:47], v[104:107], v[4:7], 0
    v_exp_f32 v48, v48
    v_exp_f32 v49, v49
    v_exp_f32 v50, v50
    v_exp_f32 v51, v51
    v_exp_f32 v52, v52
    v_cvt_pk_bf16_f32 v8, v48, v49
    v_cvt_pk_bf16_f32 v9, v50, v51
    v_exp_f32 v53, v53
    v_mfma_f32_32x32x16_bf16 v[16:31], v[196:199], v[12:15], v[16:31]
    v_exp_f32 v54, v54
    v_exp_f32 v55, v55
    v_cvt_pk_bf16_f32 v10, v52, v53
    v_exp_f32 v56, v56
    v_cvt_pk_bf16_f32 v11, v54, v55
    v_exp_f32 v57, v57
    v_exp_f32 v58, v58
    v_exp_f32 v59, v59
    v_mfma_f32_32x32x16_bf16 v[16:31], v[200:203], v[8:11], v[16:31]
    v_cvt_pk_bf16_f32 v12, v56, v57
    v_exp_f32 v60, v60
    v_exp_f32 v61, v61
    v_cvt_pk_bf16_f32 v13, v58, v59
    v_exp_f32 v62, v62
    v_exp_f32 v63, v63
    v_cvt_pk_bf16_f32 v14, v60, v61
    v_cvt_pk_bf16_f32 v15, v62, v63
    v_mfma_f32_32x32x16_bf16 v[48:63], v[108:111], v[4:7], 0
    v_exp_f32 v32, v32
    v_exp_f32 v33, v33
    v_exp_f32 v34, v34
    v_exp_f32 v35, v35
    v_exp_f32 v36, v36
    v_cvt_pk_bf16_f32 v8, v32, v33
    v_cvt_pk_bf16_f32 v9, v34, v35
    v_exp_f32 v37, v37
    v_mfma_f32_32x32x16_bf16 v[16:31], v[204:207], v[12:15], v[16:31]
    v_exp_f32 v38, v38
    v_exp_f32 v39, v39
    v_cvt_pk_bf16_f32 v10, v36, v37
    v_exp_f32 v40, v40
    v_cvt_pk_bf16_f32 v11, v38, v39
    v_exp_f32 v41, v41
    v_exp_f32 v42, v42
    v_exp_f32 v43, v43
    v_mfma_f32_32x32x16_bf16 v[16:31], v[208:211], v[8:11], v[16:31]
    v_cvt_pk_bf16_f32 v12, v40, v41
    v_exp_f32 v44, v44
    v_exp_f32 v45, v45
    v_cvt_pk_bf16_f32 v13, v42, v43
    v_exp_f32 v46, v46
    v_exp_f32 v47, v47
    v_cvt_pk_bf16_f32 v14, v44, v45
    v_cvt_pk_bf16_f32 v15, v46, v47
    v_mfma_f32_32x32x16_bf16 v[32:47], v[112:115], v[4:7], 0
    v_exp_f32 v48, v48
    v_exp_f32 v49, v49
    v_exp_f32 v50, v50
    v_exp_f32 v51, v51
    v_exp_f32 v52, v52
    v_cvt_pk_bf16_f32 v8, v48, v49
    v_cvt_pk_bf16_f32 v9, v50, v51
    v_exp_f32 v53, v53
    v_mfma_f32_32x32x16_bf16 v[16:31], v[212:215], v[12:15], v[16:31]
    v_exp_f32 v54, v54
    v_exp_f32 v55, v55
    v_cvt_pk_bf16_f32 v10, v52, v53
    v_exp_f32 v56, v56
    v_cvt_pk_bf16_f32 v11, v54, v55
    v_exp_f32 v57, v57
    v_exp_f32 v58, v58
    v_exp_f32 v59, v59
    v_mfma_f32_32x32x16_bf16 v[16:31], v[216:219], v[8:11], v[16:31]
    v_cvt_pk_bf16_f32 v12, v56, v57
    v_exp_f32 v60, v60
    v_exp_f32 v61, v61
    v_cvt_pk_bf16_f32 v13, v58, v59
    v_exp_f32 v62, v62
    v_exp_f32 v63, v63
    v_cvt_pk_bf16_f32 v14, v60, v61
    v_cvt_pk_bf16_f32 v15, v62, v63
    v_mfma_f32_32x32x16_bf16 v[48:63], v[116:119], v[4:7], 0
    v_exp_f32 v32, v32
    v_exp_f32 v33, v33
    v_exp_f32 v34, v34
    v_exp_f32 v35, v35
    v_exp_f32 v36, v36
    v_cvt_pk_bf16_f32 v8, v32, v33
    v_cvt_pk_bf16_f32 v9, v34, v35
    v_exp_f32 v37, v37
    v_mfma_f32_32x32x16_bf16 v[16:31], v[220:223], v[12:15], v[16:31]
    v_exp_f32 v38, v38
    v_exp_f32 v39, v39
    v_cvt_pk_bf16_f32 v10, v36, v37
    v_exp_f32 v40, v40
    v_cvt_pk_bf16_f32 v11, v38, v39
    v_exp_f32 v41, v41
    v_exp_f32 v42, v42
    v_exp_f32 v43, v43
    v_mfma_f32_32x32x16_bf16 v[16:31], v[224:227], v[8:11], v[16:31]
    v_cvt_pk_bf16_f32 v12, v40, v41
    v_exp_f32 v44, v44
    v_exp_f32 v45, v45
    v_cvt_pk_bf16_f32 v13, v42, v43
    v_exp_f32 v46, v46
    v_exp_f32 v47, v47
    v_cvt_pk_bf16_f32 v14, v44, v45
    v_cvt_pk_bf16_f32 v15, v46, v47
    v_mfma_f32_32x32x16_bf16 v[32:47], v[120:123], v[4:7], 0
    v_exp_f32 v48, v48
    v_exp_f32 v49, v49
    v_exp_f32 v50, v50
    v_exp_f32 v51, v51
    v_exp_f32 v52, v52
    v_cvt_pk_bf16_f32 v8, v48, v49
    v_cvt_pk_bf16_f32 v9, v50, v51
    v_exp_f32 v53, v53
    v_mfma_f32_32x32x16_bf16 v[16:31], v[228:231], v[12:15], v[16:31]
    v_exp_f32 v54, v54
    v_exp_f32 v55, v55
    v_cvt_pk_bf16_f32 v10, v52, v53
    v_exp_f32 v56, v56
    v_cvt_pk_bf16_f32 v11, v54, v55
    v_exp_f32 v57, v57
    v_exp_f32 v58, v58
    v_exp_f32 v59, v59
    v_mfma_f32_32x32x16_bf16 v[16:31], v[232:235], v[8:11], v[16:31]
    ds_read_b32 v8, v1
    v_cvt_pk_bf16_f32 v12, v56, v57
    v_exp_f32 v60, v60
    v_exp_f32 v61, v61
    v_cvt_pk_bf16_f32 v13, v58, v59
    v_exp_f32 v62, v62
    v_exp_f32 v63, v63
    v_cvt_pk_bf16_f32 v14, v60, v61
    v_cvt_pk_bf16_f32 v15, v62, v63
    v_mfma_f32_32x32x16_bf16 v[48:63], v[124:127], v[4:7], 0
    v_add_u32 v2, 1024, v2
    ds_read_b128 v[4:7], v2
    s_waitcnt lgkmcnt(1)
    v_cmp_ne_u32 vcc, -1, v8
    v_exp_f32 v32, v32
    v_exp_f32 v33, v33
    v_exp_f32 v34, v34
    v_exp_f32 v35, v35
    s_cbranch_vccnz L_await0
L_aok0:
    v_exp_f32 v36, v36
    v_cvt_pk_bf16_f32 v8, v32, v33
    v_cvt_pk_bf16_f32 v9, v34, v35
    v_exp_f32 v37, v37
    v_mfma_f32_32x32x16_bf16 v[16:31], v[236:239], v[12:15], v[16:31]
    v_exp_f32 v38, v38
    v_exp_f32 v39, v39
    v_cvt_pk_bf16_f32 v10, v36, v37
    v_exp_f32 v40, v40
    v_cvt_pk_bf16_f32 v11, v38, v39
    v_exp_f32 v41, v41
    v_exp_f32 v42, v42
    v_exp_f32 v43, v43
    v_mfma_f32_32x32x16_bf16 v[16:31], v[240:243], v[8:11], v[16:31]
    v_cvt_pk_bf16_f32 v12, v40, v41
    v_exp_f32 v44, v44
    v_exp_f32 v45, v45
    v_cvt_pk_bf16_f32 v13, v42, v43
    v_exp_f32 v46, v46
    v_exp_f32 v47, v47
    v_cvt_pk_bf16_f32 v14, v44, v45
    v_cvt_pk_bf16_f32 v15, v46, v47
    s_waitcnt lgkmcnt(0)
    v_mfma_f32_32x32x16_bf16 v[32:47], v[64:67], v[4:7], 0
    v_exp_f32 v48, v48
    v_exp_f32 v49, v49
    v_exp_f32 v50, v50
    v_exp_f32 v51, v51
    v_exp_f32 v52, v52
    v_cvt_pk_bf16_f32 v8, v48, v49
    v_cvt_pk_bf16_f32 v9, v50, v51
    v_exp_f32 v53, v53
    v_mfma_f32_32x32x16_bf16 v[16:31], v[244:247], v[12:15], v[16:31]
    v_exp_f32 v54, v54
    v_exp_f32 v55, v55
    v_cvt_pk_bf16_f32 v10, v52, v53
    v_exp_f32 v56, v56
    v_cvt_pk_bf16_f32 v11, v54, v55
    v_exp_f32 v57, v57
    v_exp_f32 v58, v58
    v_exp_f32 v59, v59
    v_mfma_f32_32x32x16_bf16 v[16:31], v[248:251], v[8:11], v[16:31]
    v_cvt_pk_bf16_f32 v12, v56, v57
    v_exp_f32 v60, v60
    v_exp_f32 v61, v61
    v_cvt_pk_bf16_f32 v13, v58, v59
    v_exp_f32 v62, v62
    v_exp_f32 v63, v63
    v_cvt_pk_bf16_f32 v14, v60, v61
    v_cvt_pk_bf16_f32 v15, v62, v63
    s_add_u32 s99, s99, 1
    s_cmp_lt_u32 s99, 8
    s_cbranch_scc1 L_attn
    v_mfma_f32_32x32x16_bf16 v[16:31], v[252:255], v[12:15], v[16:31]
    s_nop 11
    ds_write_b128 v3, v[16:19]
    ds_write_b128 v3, v[20:23] offset:1024
    ds_write_b32 v1, v24
L_a_post:
    s_waitcnt lgkmcnt(0)
    s_barrier
    s_lshl_b32 s75, s69, 13
    s_mul_i32 s73, s66, 176128
    s_mul_i32 s74, s69, 6144
    s_add_u32 s73, s73, s74
    s_add_u32 s73, s73, 17367040
    s_add_u32 m0, s75, 98304
    s_add_u32 s74, s73, 88064
    buffer_load_dwordx4 v0, s[60:63], s73 offen offset:0 lds
    buffer_load_dwordx4 v0, s[60:63], s73 offen offset:1024 lds
    buffer_load_dwordx4 v0, s[60:63], s73 offen offset:2048 lds
    buffer_load_dwordx4 v0, s[60:63], s73 offen offset:3072 lds
    s_add_u32 m0, m0, 4096
    s_nop 0
    buffer_load_dwordx4 v0, s[60:63], s74 offen offset:0 lds
    buffer_load_dwordx4 v0, s[60:63], s74 offen offset:1024 lds
    buffer_load_dwordx4 v0, s[60:63], s74 offen offset:2048 lds
    buffer_load_dwordx4 v0, s[60:63], s74 offen offset:3072 lds
    s_barrier
    s_mov_b32 s98, 0
L_lw_7:
    v_mov_b32 v8, 132124
    ds_read_b32 v8, v8
    s_add_u32 s98, s98, 1
    s_cmp_gt_u32 s98, 1048576
    s_cbranch_scc1 L_end
    s_waitcnt lgkmcnt(0)
    v_readfirstlane_b32 s79, v8
    s_nop 0
    s_cmp_ge_u32 s79, 1
    s_cbranch_scc0 L_lw_7
    s_mov_b32 s28, s79
    s_barrier
    v_mov_b32 v8, 132128
    ds_read_b32 v8, v8
    s_lshr_b32 s72, s65, 4
    s_lshl_b32 s72, s72, 2
    s_add_u32 s72, s72, s64
    s_lshl_b32 s74, s72, 15
    s_add_u32 s74, s74, 3145728
    s_mul_i32 s75, s72, 88064
    s_lshl_b32 s76, s68, 11
    s_add_u32 s75, s75, s76
    s_add_u32 s75, s75, 9437184
    s_waitcnt lgkmcnt(0)
    v_readfirstlane_b32 s72, v8
    s_nop 0
    s_cmp_lg_u32 s72, s101
    s_cbranch_scc1 L_a_safe
    s_lshl_b32 s76, s64, 2
    s_add_u32 s76, s76, 132480
    v_mov_b32 v1, s76
    v_add_u32 v2, 65536, v0
    s_add_u32 s80, s74, 0
    s_add_u32 s81, s74, 4096
    s_add_u32 s82, s74, 8192
    s_add_u32 s83, s74, 12288
    s_add_u32 s84, s74, 16384
    s_add_u32 s85, s74, 20480
    s_add_u32 s86, s74, 24576
    s_add_u32 s87, s74, 28672
    s_waitcnt vmcnt(0)
    v_mov_b32 v4, 132496
    v_mov_b32 v5, 1
    s_mov_b64 exec, 1
    ds_add_u32 v4, v5
    s_mov_b64 exec, -1
    s_mov_b32 s98, 0
L_f1_again:
    s_waitcnt lgkmcnt(0)
    ds_read_b128 v[64:67], v0 offset:2048
    ds_read_b128 v[68:71], v0 offset:34816
    ds_read_b128 v[72:75], v0 offset:10240
    ds_read_b128 v[76:79], v0 offset:43008
    ds_read_b128 v[80:83], v0 offset:18432
    ds_read_b128 v[84:87], v0 offset:51200
L_f1_probe:
    buffer_load_dwordx4 v[136:139], v0, s[60:63], s80 offen offset:2048 sc1
    buffer_load_dwordx4 v[168:171], v0, s[60:63], s82 offen offset:2048 sc1
    buffer_load_dwordx4 v[200:203], v0, s[60:63], s84 offen offset:2048 sc1
    buffer_load_dwordx4 v[232:235], v0, s[60:63], s86 offen offset:2048 sc1
    s_add_u32 s98, s98, 1
    s_cmp_gt_u32 s98, 1048576
    s_cbranch_scc1 L_end
    s_waitcnt vmcnt(0)
    v_max_u32 v4, v136, v168
    v_max3_u32 v4, v4, v200, v232
    v_cmp_eq_u32 vcc, -1, v4
    s_cbranch_vccnz L_f1_probe
    buffer_load_dwordx4 v[128:131], v0, s[60:63], s80 offen offset:0 sc1
    buffer_load_dwordx4 v[132:135], v0, s[60:63], s80 offen offset:1024 sc1
    buffer_load_dwordx4 v[140:143], v0, s[60:63], s80 offen offset:3072 sc1
    buffer_load_dwordx4 v[144:147], v0, s[60:63], s81 offen offset:0 sc1
    buffer_load_dwordx4 v[148:151], v0, s[60:63], s81 offen offset:1024 sc1
    buffer_load_dwordx4 v[152:155], v0, s[60:63], s81 offen offset:2048 sc1
    buffer_load_dwordx4 v[156:159], v0, s[60:63], s81 offen offset:3072 sc1
    buffer_load_dwordx4 v[160:163], v0, s[60:63], s82 offen offset:0 sc1
    buffer_load_dwordx4 v[164:167], v0, s[60:63], s82 offen offset:1024 sc1
    buffer_load_dwordx4 v[172:175], v0, s[60:63], s82 offen offset:3072 sc1
    s_setprio 2
    ds_read_b128 v[88:91], v0 offset:26624
    ds_read_b128 v[92:95], v0 offset:59392
    s_waitcnt vmcnt(10) lgkmcnt(6)
    v_mfma_f32_32x32x16_bf16 v[32:47], v[64:67], v[136:139], 0
    buffer_load_dwordx4 v[176:179], v0, s[60:63], s83 offen offset:0 sc1
    v_mfma_f32_32x32x16_bf16 v[48:63], v[68:71], v[136:139], 0
    ds_read_b128 v[64:67], v0 offset:0
    ds_read_b128 v[68:71], v0 offset:32768
    s_waitcnt vmcnt(11) lgkmcnt(6)
    v_mfma_f32_32x32x16_bf16 v[32:47], v[72:75], v[168:171], v[32:47]
    buffer_load_dwordx4 v[180:183], v0, s[60:63], s83 offen offset:1024 sc1
    v_mfma_f32_32x32x16_bf16 v[48:63], v[76:79], v[168:171], v[48:63]
    ds_read_b128 v[72:75], v0 offset:1024
    ds_read_b128 v[76:79], v0 offset:33792
    s_waitcnt vmcnt(12) lgkmcnt(6)
    v_mfma_f32_32x32x16_bf16 v[32:47], v[80:83], v[200:203], v[32:47]
    buffer_load_dwordx4 v[184:187], v0, s[60:63], s83 offen offset:2048 sc1
    v_mfma_f32_32x32x16_bf16 v[48:63], v[84:87], v[200:203], v[48:63]
    ds_read_b128 v[80:83], v0 offset:3072
    ds_read_b128 v[84:87], v0 offset:35840
    s_waitcnt vmcnt(13) lgkmcnt(6)
    v_mfma_f32_32x32x16_bf16 v[32:47], v[88:91], v[232:235], v[32:47]
    buffer_load_dwordx4 v[188:191], v0, s[60:63], s83 offen offset:3072 sc1
    v_mfma_f32_32x32x16_bf16 v[48:63], v[92:95], v[232:235], v[48:63]
    ds_read_b128 v[88:91], v0 offset:4096
    ds_read_b128 v[92:95], v0 offset:36864
    s_waitcnt vmcnt(13) lgkmcnt(6)
    v_mfma_f32_32x32x16_bf16 v[32:47], v[64:67], v[128:131], v[32:47]
    buffer_load_dwordx4 v[192:195], v0, s[60:63], s84 offen offset:0 sc1
    v_mfma_f32_32x32x16_bf16 v[48:63], v[68:71], v[128:131], v[48:63]
    ds_read_b128 v[64:67], v0 offset:5120
    ds_read_b128 v[68:71], v0 offset:37888
    s_waitcnt vmcnt(13) lgkmcnt(6)
    v_mfma_f32_32x32x16_bf16 v[32:47], v[72:75], v[132:135], v[32:47]
    buffer_load_dwordx4 v[196:199], v0, s[60:63], s84 offen offset:1024 sc1
    v_mfma_f32_32x32x16_bf16 v[48:63], v[76:79], v[132:135], v[48:63]
    v_max3_u32 v4, v4, v132, v128
    ds_read_b128 v[72:75], v0 offset:6144
    ds_read_b128 v[76:79], v0 offset:38912
    s_waitcnt vmcnt(13) lgkmcnt(6)
    v_mfma_f32_32x32x16_bf16 v[32:47], v[80:83], v[140:143], v[32:47]
    buffer_load_dwordx4 v[204:207], v0, s[60:63], s84 offen offset:3072 sc1
    v_mfma_f32_32x32x16_bf16 v[48:63], v[84:87], v[140:143], v[48:63]
    ds_read_b128 v[80:83], v0 offset:7168
    ds_read_b128 v[84:87], v0 offset:39936
    s_waitcnt vmcnt(13) lgkmcnt(6)
    v_mfma_f32_32x32x16_bf16 v[32:47], v[88:91], v[144:147], v[32:47]
    buffer_load_dwordx4 v[208:211], v0, s[60:63], s85 offen offset:0 sc1
    v_mfma_f32_32x32x16_bf16 v[48:63], v[92:95], v[144:147], v[48:63]
    v_max3_u32 v4, v4, v144, v140
    ds_read_b128 v[88:91], v0 offset:8192
    ds_read_b128 v[92:95], v0 offset:40960
    s_waitcnt vmcnt(13) lgkmcnt(6)
    v_mfma_f32_32x32x16_bf16 v[32:47], v[64:67], v[148:151], v[32:47]
    buffer_load_dwordx4 v[212:215], v0, s[60:63], s85 offen offset:1024 sc1
    v_mfma_f32_32x32x16_bf16 v[48:63], v[68:71], v[148:151], v[48:63]
    ds_read_b128 v[64:67], v0 offset:9216
    ds_read_b128 v[68:71], v0 offset:41984
    s_waitcnt vmcnt(13) lgkmcnt(6)
    v_mfma_f32_32x32x16_bf16 v[32:47], v[72:75], v[152:155], v[32:47]
    buffer_load_dwordx4 v[216:219], v0, s[60:63], s85 offen offset:2048 sc1
    v_mfma_f32_32x32x16_bf16 v[48:63], v[76:79], v[152:155], v[48:63]
    v_max3_u32 v4, v4, v152, v148
    ds_read_b128 v[72:75], v0 offset:11264
    ds_read_b128 v[76:79], v0 offset:44032
    s_waitcnt vmcnt(13) lgkmcnt(6)
    v_mfma_f32_32x32x16_bf16 v[32:47], v[80:83], v[156:159], v[32:47]
    buffer_load_dwordx4 v[220:223], v0, s[60:63], s85 offen offset:3072 sc1
    v_mfma_f32_32x32x16_bf16 v[48:63], v[84:87], v[156:159], v[48:63]
    ds_read_b128 v[80:83], v0 offset:12288
    ds_read_b128 v[84:87], v0 offset:45056
    s_waitcnt vmcnt(13) lgkmcnt(6)
    v_mfma_f32_32x32x16_bf16 v[32:47], v[88:91], v[160:163], v[32:47]
    buffer_load_dwordx4 v[224:227], v0, s[60:63], s86 offen offset:0 sc1
    v_mfma_f32_32x32x16_bf16 v[48:63], v[92:95], v[160:163], v[48:63]
    v_max3_u32 v4, v4, v160, v156
    ds_read_b128 v[88:91], v0 offset:13312
    ds_read_b128 v[92:95], v0 offset:46080
    s_waitcnt vmcnt(13) lgkmcnt(6)
    v_mfma_f32_32x32x16_bf16 v[32:47], v[64:67], v[164:167], v[32:47]
    buffer_load_dwordx4 v[228:231], v0, s[60:63], s86 offen offset:1024 sc1
    v_mfma_f32_32x32x16_bf16 v[48:63], v[68:71], v[164:167], v[48:63]
    ds_read_b128 v[64:67], v0 offset:14336
    ds_read_b128 v[68:71], v0 offset:47104
    s_waitcnt vmcnt(13) lgkmcnt(6)
    v_mfma_f32_32x32x16_bf16 v[32:47], v[72:75], v[172:175], v[32:47]
    buffer_load_dwordx4 v[236:239], v0, s[60:63], s86 offen offset:3072 sc1
    v_mfma_f32_32x32x16_bf16 v[48:63], v[76:79], v[172:175], v[48:63]
    v_max3_u32 v4, v4, v172, v164
    ds_read_b128 v[72:75], v0 offset:15360
    ds_read_b128 v[76:79], v0 offset:48128
    s_waitcnt vmcnt(13) lgkmcnt(6)
    v_mfma_f32_32x32x16_bf16 v[32:47], v[80:83], v[176:179], v[32:47]
    buffer_load_dwordx4 v[240:243], v0, s[60:63], s87 offen offset:0 sc1
    v_mfma_f32_32x32x16_bf16 v[48:63], v[84:87], v[176:179], v[48:63]
    ds_read_b128 v[80:83], v0 offset:16384
    ds_read_b128 v[84:87], v0 offset:49152
    s_waitcnt vmcnt(13) lgkmcnt(6)
    v_mfma_f32_32x32x16_bf16 v[32:47], v[88:91], v[180:183], v[32:47]
    buffer_load_dwordx4 v[244:247], v0, s[60:63], s87 offen offset:1024 sc1
    v_mfma_f32_32x32x16_bf16 v[48:63], v[92:95], v[180:183], v[48:63]
    v_max3_u32 v4, v4, v180, v176
    ds_read_b128 v[88:91], v0 offset:17408
    ds_read_b128 v[92:95], v0 offset:50176
    s_waitcnt vmcnt(13) lgkmcnt(6)
    v_mfma_f32_32x32x16_bf16 v[32:47], v[64:67], v[184:187], v[32:47]
    buffer_load_dwordx4 v[248:251], v0, s[60:63], s87 offen offset:2048 sc1
    v_mfma_f32_32x32x16_bf16 v[48:63], v[68:71], v[184:187], v[48:63]
    ds_read_b128 v[64:67], v0 offset:19456
    ds_read_b128 v[68:71], v0 offset:52224
    s_waitcnt vmcnt(13) lgkmcnt(6)
    v_mfma_f32_32x32x16_bf16 v[32:47], v[72:75], v[188:191], v[32:47]
    buffer_load_dwordx4 v[252:255], v0, s[60:63], s87 offen offset:3072 sc1
    v_mov_b32 v6, 132504
    v_mov_b32 v7, 1
    s_mov_b64 exec, 1
    ds_add_u32 v6, v7
    s_mov_b64 exec, -1
    v_mfma_f32_32x32x16_bf16 v[48:63], v[76:79], v[188:191], v[48:63]
    v_max3_u32 v4, v4, v188, v184
    ds_read_b128 v[72:75], v0 offset:20480
    ds_read_b128 v[76:79], v0 offset:53248
    s_waitcnt vmcnt(13) lgkmcnt(6)
    v_mfma_f32_32x32x16_bf16 v[32:47], v[80:83], v[192:195], v[32:47]
    v_mfma_f32_32x32x16_bf16 v[48:63], v[84:87], v[192:195], v[48:63]
    ds_read_b128 v[80:83], v0 offset:21504
    ds_read_b128 v[84:87], v0 offset:54272
    s_waitcnt vmcnt(12) lgkmcnt(6)
    v_mfma_f32_32x32x16_bf16 v[32:47], v[88:91], v[196:199], v[32:47]
    v_mfma_f32_32x32x16_bf16 v[48:63], v[92:95], v[196:199], v[48:63]
    v_max3_u32 v4, v4, v196, v192
    v_mov_b32 v5, 132496
    ds_read_b32 v5, v5
    ds_read_b128 v[88:91], v0 offset:22528
    ds_read_b128 v[92:95], v0 offset:55296
    s_waitcnt vmcnt(11) lgkmcnt(6)
    v_mfma_f32_32x32x16_bf16 v[32:47], v[64:67], v[204:207], v[32:47]
    v_mfma_f32_32x32x16_bf16 v[48:63], v[68:71], v[204:207], v[48:63]
    ds_read_b128 v[64:67], v0 offset:23552
    ds_read_b128 v[68:71], v0 offset:56320
    s_waitcnt vmcnt(10) lgkmcnt(6)
    v_mfma_f32_32x32x16_bf16 v[32:47], v[72:75], v[208:211], v[32:47]
    v_mfma_f32_32x32x16_bf16 v[48:63], v[76:79], v[208:211], v[48:63]
    v_max3_u32 v4, v4, v208, v204
    ds_read_b128 v[72:75], v0 offset:24576
    ds_read_b128 v[76:79], v0 offset:57344
    s_waitcnt vmcnt(9) lgkmcnt(6)
    v_mfma_f32_32x32x16_bf16 v[32:47], v[80:83], v[212:215], v[32:47]
    v_mfma_f32_32x32x16_bf16 v[48:63], v[84:87], v[212:215], v[48:63]
    ds_read_b128 v[80:83], v0 offset:25600
    ds_read_b128 v[84:87], v0 offset:58368
    s_waitcnt vmcnt(8) lgkmcnt(6)
    v_mfma_f32_32x32x16_bf16 v[32:47], v[88:91], v[216:219], v[32:47]
    v_mfma_f32_32x32x16_bf16 v[48:63], v[92:95], v[216:219], v[48:63]
    v_max3_u32 v4, v4, v216, v212
    ds_read_b128 v[88:91], v0 offset:27648
    ds_read_b128 v[92:95], v0 offset:60416
    s_waitcnt vmcnt(7) lgkmcnt(6)
    v_mfma_f32_32x32x16_bf16 v[32:47], v[64:67], v[220:223], v[32:47]
    v_mfma_f32_32x32x16_bf16 v[48:63], v[68:71], v[220:223], v[48:63]
    ds_read_b128 v[64:67], v0 offset:28672
    ds_read_b128 v[68:71], v0 offset:61440
    s_waitcnt vmcnt(6) lgkmcnt(6)
    v_mfma_f32_32x32x16_bf16 v[32:47], v[72:75], v[224:227], v[32:47]
    v_mfma_f32_32x32x16_bf16 v[48:63], v[76:79], v[224:227], v[48:63]
    v_max3_u32 v4, v4, v224, v220
    ds_read_b128 v[72:75], v0 offset:29696
    ds_read_b128 v[76:79], v0 offset:62464
    s_waitcnt vmcnt(5) lgkmcnt(6)
    v_mfma_f32_32x32x16_bf16 v[32:47], v[80:83], v[228:231], v[32:47]
    v_mfma_f32_32x32x16_bf16 v[48:63], v[84:87], v[228:231], v[48:63]
    ds_read_b128 v[80:83], v0 offset:30720
    ds_read_b128 v[84:87], v0 offset:63488
    s_waitcnt vmcnt(4) lgkmcnt(6)
    v_mfma_f32_32x32x16_bf16 v[32:47], v[88:91], v[236:239], v[32:47]
    v_mfma_f32_32x32x16_bf16 v[48:63], v[92:95], v[236:239], v[48:63]
    v_max3_u32 v4, v4, v236, v228
L_f1_ld:
    v_readfirstlane_b32 s72, v5
    s_nop 0
    s_cmp_ge_u32 s72, 8
    s_cbranch_scc0 L_f1_ldw
    ds_read_b128 v[88:91], v0 offset:31744
    ds_read_b128 v[92:95], v0 offset:64512
    s_waitcnt vmcnt(3) lgkmcnt(6)
    v_mfma_f32_32x32x16_bf16 v[32:47], v[64:67], v[240:243], v[32:47]
    v_mfma_f32_32x32x16_bf16 v[48:63], v[68:71], v[240:243], v[48:63]
    ds_read_b128 v[64:67], v2 offset:0
    ds_read_b128 v[68:71], v2 offset:1024
    s_waitcnt vmcnt(2) lgkmcnt(6)
    v_mfma_f32_32x32x16_bf16 v[32:47], v[72:75], v[244:247], v[32:47]
    v_mfma_f32_32x32x16_bf16 v[48:63], v[76:79], v[244:247], v[48:63]
    v_max3_u32 v4, v4, v244, v240
    ds_read_b128 v[72:75], v2 offset:2048
    ds_read_b128 v[76:79], v2 offset:3072
    s_waitcnt vmcnt(1) lgkmcnt(6)
    v_mfma_f32_32x32x16_bf16 v[32:47], v[80:83], v[248:251], v[32:47]
    v_mfma_f32_32x32x16_bf16 v[48:63], v[84:87], v[248:251], v[48:63]
    ds_read_b128 v[80:83], v2 offset:4096
    ds_read_b128 v[84:87], v2 offset:5120
    s_waitcnt vmcnt(0) lgkmcnt(6)
    v_mfma_f32_32x32x16_bf16 v[32:47], v[88:91], v[252:255], v[32:47]
    v_mfma_f32_32x32x16_bf16 v[48:63], v[92:95], v[252:255], v[48:63]
    v_max3_u32 v4, v4, v252, v248
    v_cmp_eq_u32 vcc, -1, v4
    s_cbranch_vccnz L_f1_again
    s_cmp_lt_u32 s68, 11
    s_cbranch_scc0 L_f1_two
    ds_read_b128 v[88:91], v2 offset:6144
    ds_read_b128 v[92:95], v2 offset:7168
    s_waitcnt lgkmcnt(6)
    v_mfma_f32_32x32x16_bf16 v[96:111], v[64:67], v[128:131], 0
    v_mfma_f32_32x32x16_bf16 v[96:111], v[68:71], v[132:135], v[96:111]
    ds_read_b128 v[64:67], v2 offset:8192
    ds_read_b128 v[68:71], v2 offset:9216
    s_waitcnt lgkmcnt(6)
    v_mfma_f32_32x32x16_bf16 v[96:111], v[72:75], v[136:139], v[96:111]
    v_exp_f32 v16, v32
    v_exp_f32 v17, v33
    v_exp_f32 v18, v34
    v_exp_f32 v19, v35
    v_exp_f32 v20, v36
    v_exp_f32 v21, v37
    v_exp_f32 v22, v38
    v_exp_f32 v23, v39
    v_mfma_f32_32x32x16_bf16 v[96:111], v[76:79], v[140:143], v[96:111]
    v_exp_f32 v24, v40
    v_exp_f32 v25, v41
    v_exp_f32 v26, v42
    v_exp_f32 v27, v43
    v_exp_f32 v28, v44
    v_exp_f32 v29, v45
    v_exp_f32 v30, v46
    ds_read_b128 v[72:75], v2 offset:10240
    ds_read_b128 v[76:79], v2 offset:11264
    s_waitcnt lgkmcnt(6)
    v_mfma_f32_32x32x16_bf16 v[96:111], v[80:83], v[144:147], v[96:111]
    v_exp_f32 v31, v47
    v_add_f32 v16, 1.0, v16
    v_add_f32 v17, 1.0, v17
    v_add_f32 v18, 1.0, v18
    v_add_f32 v19, 1.0, v19
    v_add_f32 v20, 1.0, v20
    v_add_f32 v21, 1.0, v21
    v_add_f32 v22, 1.0, v22
    v_add_f32 v23, 1.0, v23
    v_add_f32 v24, 1.0, v24
    v_add_f32 v25, 1.0, v25
    v_add_f32 v26, 1.0, v26
    v_add_f32 v27, 1.0, v27
    v_add_f32 v28, 1.0, v28
    v_add_f32 v29, 1.0, v29
    v_mfma_f32_32x32x16_bf16 v[96:111], v[84:87], v[148:151], v[96:111]
    v_add_f32 v30, 1.0, v30
    v_add_f32 v31, 1.0, v31
    v_rcp_f32 v16, v16
    v_rcp_f32 v17, v17
    v_rcp_f32 v18, v18
    v_rcp_f32 v19, v19
    v_rcp_f32 v20, v20
    v_rcp_f32 v21, v21
    ds_read_b128 v[80:83], v2 offset:12288
    ds_read_b128 v[84:87], v2 offset:13312
    s_waitcnt lgkmcnt(6)
    v_mfma_f32_32x32x16_bf16 v[96:111], v[88:91], v[152:155], v[96:111]
    v_rcp_f32 v22, v22
    v_rcp_f32 v23, v23
    v_rcp_f32 v24, v24
    v_rcp_f32 v25, v25
    v_rcp_f32 v26, v26
    v_rcp_f32 v27, v27
    v_rcp_f32 v28, v28
    v_rcp_f32 v29, v29
    v_mfma_f32_32x32x16_bf16 v[96:111], v[92:95], v[156:159], v[96:111]
    v_rcp_f32 v30, v30
    v_rcp_f32 v31, v31
    v_mul_f32 v16, v32, v16
    v_mul_f32 v17, v33, v17
    v_mul_f32 v18, v34, v18
    v_mul_f32 v19, v35, v19
    v_mul_f32 v20, v36, v20
    v_mul_f32 v21, v37, v21
    v_mul_f32 v22, v38, v22
    v_mul_f32 v23, v39, v23
    v_mul_f32 v24, v40, v24
    v_mul_f32 v25, v41, v25
    ds_read_b128 v[88:91], v2 offset:14336
    ds_read_b128 v[92:95], v2 offset:15360
    s_waitcnt lgkmcnt(6)
    v_mfma_f32_32x32x16_bf16 v[96:111], v[64:67], v[160:163], v[96:111]
    v_mul_f32 v26, v42, v26
    v_mul_f32 v27, v43, v27
    v_mul_f32 v28, v44, v28
    v_mul_f32 v29, v45, v29
    v_mul_f32 v30, v46, v30
    v_mul_f32 v31, v47, v31
    v_cvt_pk_bf16_f32 v8, v16, v17
    v_cvt_pk_bf16_f32 v9, v18, v19
    v_cvt_pk_bf16_f32 v10, v20, v21
    v_cvt_pk_bf16_f32 v11, v22, v23
    v_cvt_pk_bf16_f32 v12, v24, v25
    v_cvt_pk_bf16_f32 v13, v26, v27
    v_cvt_pk_bf16_f32 v14, v28, v29
    v_cvt_pk_bf16_f32 v15, v30, v31
    v_min_u32 v8, -2, v8
    v_min_u32 v12, -2, v12
    v_mfma_f32_32x32x16_bf16 v[96:111], v[68:71], v[164:167], v[96:111]
    s_cmp_eq_u32 s28, 2
    s_cbranch_scc0 L_ls_8s
    buffer_store_dwordx4 v[8:11], v0, s[60:63], s75 offen nt
    buffer_store_dwordx4 v[12:15], v0, s[60:63], s75 offen offset:1024 nt
L_ls_8b:
    s_add_u32 s75, s75, 32768
    ds_write_b32 v1, v1
    v_exp_f32 v16, v48
    v_exp_f32 v17, v49
    v_exp_f32 v18, v50
    ds_read_b128 v[64:67], v2 offset:16384
    ds_read_b128 v[68:71], v2 offset:17408
    s_waitcnt lgkmcnt(6)
    v_mfma_f32_32x32x16_bf16 v[96:111], v[72:75], v[168:171], v[96:111]
    v_exp_f32 v19, v51
    v_exp_f32 v20, v52
    v_exp_f32 v21, v53
    v_exp_f32 v22, v54
    v_exp_f32 v23, v55
    v_exp_f32 v24, v56
    v_exp_f32 v25, v57
    v_exp_f32 v26, v58
    v_mfma_f32_32x32x16_bf16 v[96:111], v[76:79], v[172:175], v[96:111]
    v_exp_f32 v27, v59
    v_exp_f32 v28, v60
    v_exp_f32 v29, v61
    v_exp_f32 v30, v62
    v_exp_f32 v31, v63
    v_add_f32 v16, 1.0, v16
    v_add_f32 v17, 1.0, v17
    v_add_f32 v18, 1.0, v18
    v_add_f32 v19, 1.0, v19
    ds_read_b128 v[72:75], v2 offset:18432
    ds_read_b128 v[76:79], v2 offset:19456
    s_waitcnt lgkmcnt(6)
    v_mfma_f32_32x32x16_bf16 v[96:111], v[80:83], v[176:179], v[96:111]
    v_add_f32 v20, 1.0, v20
    v_add_f32 v21, 1.0, v21
    v_add_f32 v22, 1.0, v22
    v_add_f32 v23, 1.0, v23
    v_add_f32 v24, 1.0, v24
    v_add_f32 v25, 1.0, v25
    v_add_f32 v26, 1.0, v26
    v_add_f32 v27, 1.0, v27
    v_add_f32 v28, 1.0, v28
    v_add_f32 v29, 1.0, v29
    v_add_f32 v30, 1.0, v30
    v_add_f32 v31, 1.0, v31
    v_rcp_f32 v16, v16
    v_rcp_f32 v17, v17
    v_mfma_f32_32x32x16_bf16 v[96:111], v[84:87], v[180:183], v[96:111]
    v_rcp_f32 v18, v18
    v_rcp_f32 v19, v19
    v_rcp_f32 v20, v20
    v_rcp_f32 v21, v21
    v_rcp_f32 v22, v22
    v_rcp_f32 v23, v23
    v_rcp_f32 v24, v24
    ds_read_b128 v[80:83], v2 offset:20480
    ds_read_b128 v[84:87], v2 offset:21504
    s_waitcnt lgkmcnt(6)
    v_mfma_f32_32x32x16_bf16 v[96:111], v[88:91], v[184:187], v[96:111]
    v_rcp_f32 v25, v25
    v_rcp_f32 v26, v26
    v_rcp_f32 v27, v27
    v_rcp_f32 v28, v28
    v_rcp_f32 v29, v29
    v_rcp_f32 v30, v30
    v_rcp_f32 v31, v31
    v_mul_f32 v16, v48, v16
    v_mul_f32 v17, v49, v17
    v_mfma_f32_32x32x16_bf16 v[96:111], v[92:95], v[188:191], v[96:111]
    v_mul_f32 v18, v50, v18
    v_mul_f32 v19, v51, v19
    v_mul_f32 v20, v52, v20
    v_mul_f32 v21, v53, v21
    v_mul_f32 v22, v54, v22
    v_mul_f32 v23, v55, v23
    v_mul_f32 v24, v56, v24
    v_mul_f32 v25, v57, v25
    v_mul_f32 v26, v58, v26
    v_mul_f32 v27, v59, v27
    v_mul_f32 v28, v60, v28
    v_mul_f32 v29, v61, v29
    v_mul_f32 v30, v62, v30
    v_mul_f32 v31, v63, v31
    ds_read_b128 v[88:91], v2 offset:22528
    ds_read_b128 v[92:95], v2 offset:23552
    s_waitcnt lgkmcnt(6)
    v_mfma_f32_32x32x16_bf16 v[96:111], v[64:67], v[192:195], v[96:111]
    v_cvt_pk_bf16_f32 v8, v16, v17
    v_cvt_pk_bf16_f32 v9, v18, v19
    v_cvt_pk_bf16_f32 v10, v20, v21
    v_cvt_pk_bf16_f32 v11, v22, v23
    v_cvt_pk_bf16_f32 v12, v24, v25
    v_cvt_pk_bf16_f32 v13, v26, v27
    v_cvt_pk_bf16_f32 v14, v28, v29
    v_cvt_pk_bf16_f32 v15, v30, v31
    v_min_u32 v8, -2, v8
    v_min_u32 v12, -2, v12
    s_cmp_eq_u32 s28, 2
    s_cbranch_scc0 L_ls_9s
    buffer_store_dwordx4 v[8:11], v0, s[60:63], s75 offen nt
    buffer_store_dwordx4 v[12:15], v0, s[60:63], s75 offen offset:1024 nt
L_ls_9b:
    s_add_u32 s75, s75, 32768
    v_mfma_f32_32x32x16_bf16 v[96:111], v[68:71], v[196:199], v[96:111]
    ds_read_b128 v[64:67], v2 offset:24576
    ds_read_b128 v[68:71], v2 offset:25600
    s_waitcnt lgkmcnt(6)
    v_mfma_f32_32x32x16_bf16 v[96:111], v[72:75], v[200:203], v[96:111]
    v_mfma_f32_32x32x16_bf16 v[96:111], v[76:79], v[204:207], v[96:111]
    ds_read_b128 v[72:75], v2 offset:26624
    ds_read_b128 v[76:79], v2 offset:27648
    s_waitcnt lgkmcnt(6)
    v_mfma_f32_32x32x16_bf16 v[96:111], v[80:83], v[208:211], v[96:111]
    v_mfma_f32_32x32x16_bf16 v[96:111], v[84:87], v[212:215], v[96:111]
    ds_read_b128 v[80:83], v2 offset:28672
    ds_read_b128 v[84:87], v2 offset:29696
    s_waitcnt lgkmcnt(6)
    v_mfma_f32_32x32x16_bf16 v[96:111], v[88:91], v[216:219], v[96:111]
    v_mfma_f32_32x32x16_bf16 v[96:111], v[92:95], v[220:223], v[96:111]
    ds_read_b128 v[88:91], v2 offset:30720
    ds_read_b128 v[92:95], v2 offset:31744
    s_waitcnt lgkmcnt(6)
    v_mfma_f32_32x32x16_bf16 v[96:111], v[64:67], v[224:227], v[96:111]
    v_mfma_f32_32x32x16_bf16 v[96:111], v[68:71], v[228:231], v[96:111]
    s_waitcnt lgkmcnt(4)
    v_mfma_f32_32x32x16_bf16 v[96:111], v[72:75], v[232:235], v[96:111]
    v_mfma_f32_32x32x16_bf16 v[96:111], v[76:79], v[236:239], v[96:111]
    s_waitcnt lgkmcnt(2)
    v_mfma_f32_32x32x16_bf16 v[96:111], v[80:83], v[240:243], v[96:111]
    v_mfma_f32_32x32x16_bf16 v[96:111], v[84:87], v[244:247], v[96:111]
    s_waitcnt lgkmcnt(0)
    v_mfma_f32_32x32x16_bf16 v[96:111], v[88:91], v[248:251], v[96:111]
    v_mfma_f32_32x32x16_bf16 v[96:111], v[92:95], v[252:255], v[96:111]
    s_nop 11
    v_exp_f32 v16, v96
    v_exp_f32 v17, v97
    v_exp_f32 v18, v98
    v_exp_f32 v19, v99
    v_exp_f32 v20, v100
    v_exp_f32 v21, v101
    v_exp_f32 v22, v102
    v_exp_f32 v23, v103
    v_exp_f32 v24, v104
    v_exp_f32 v25, v105
    v_exp_f32 v26, v106
    v_exp_f32 v27, v107
    v_exp_f32 v28, v108
    v_exp_f32 v29, v109
    v_exp_f32 v30, v110
    v_exp_f32 v31, v111
    v_add_f32 v16, 1.0, v16
    v_add_f32 v17, 1.0, v17
    v_add_f32 v18, 1.0, v18
    v_add_f32 v19, 1.0, v19
    v_add_f32 v20, 1.0, v20
    v_add_f32 v21, 1.0, v21
    v_add_f32 v22, 1.0, v22
    v_add_f32 v23, 1.0, v23
    v_add_f32 v24, 1.0, v24
    v_add_f32 v25, 1.0, v25
    v_add_f32 v26, 1.0, v26
    v_add_f32 v27, 1.0, v27
    v_add_f32 v28, 1.0, v28
    v_add_f32 v29, 1.0, v29
    v_add_f32 v30, 1.0, v30
    v_add_f32 v31, 1.0, v31
    v_rcp_f32 v16, v16
    v_rcp_f32 v17, v17
    v_rcp_f32 v18, v18
    v_rcp_f32 v19, v19
    v_rcp_f32 v20, v20
    v_rcp_f32 v21, v21
    v_rcp_f32 v22, v22
    v_rcp_f32 v23, v23
    v_rcp_f32 v24, v24
    v_rcp_f32 v25, v25
    v_rcp_f32 v26, v26
    v_rcp_f32 v27, v27
    v_rcp_f32 v28, v28
    v_rcp_f32 v29, v29
    v_rcp_f32 v30, v30
    v_rcp_f32 v31, v31
    v_mul_f32 v16, v96, v16
    v_mul_f32 v17, v97, v17
    v_mul_f32 v18, v98, v18
    v_mul_f32 v19, v99, v19
    v_mul_f32 v20, v100, v20
    v_mul_f32 v21, v101, v21
    v_mul_f32 v22, v102, v22
    v_mul_f32 v23, v103, v23
    v_mul_f32 v24, v104, v24
    v_mul_f32 v25, v105, v25
    v_mul_f32 v26, v106, v26
    v_mul_f32 v27, v107, v27
    v_mul_f32 v28, v108, v28
    v_mul_f32 v29, v109, v29
    v_mul_f32 v30, v110, v30
    v_mul_f32 v31, v111, v31
    v_cvt_pk_bf16_f32 v8, v16, v17
    v_cvt_pk_bf16_f32 v9, v18, v19
    v_cvt_pk_bf16_f32 v10, v20, v21
    v_cvt_pk_bf16_f32 v11, v22, v23
    v_cvt_pk_bf16_f32 v12, v24, v25
    v_cvt_pk_bf16_f32 v13, v26, v27
    v_cvt_pk_bf16_f32 v14, v28, v29
    v_cvt_pk_bf16_f32 v15, v30, v31
    v_min_u32 v8, -2, v8
    v_min_u32 v12, -2, v12
    s_cmp_eq_u32 s28, 2
    s_cbranch_scc0 L_ls_10s
    buffer_store_dwordx4 v[8:11], v0, s[60:63], s75 offen nt
    buffer_store_dwordx4 v[12:15], v0, s[60:63], s75 offen offset:1024 nt
L_ls_10b:
    s_add_u32 s75, s75, 32768
    s_branch L_f1_done
L_f1_two:
    s_nop 5
    v_exp_f32 v16, v32
    v_exp_f32 v17, v33
    v_exp_f32 v18, v34
    v_exp_f32 v19, v35
    v_exp_f32 v20, v36
    v_exp_f32 v21, v37
    v_exp_f32 v22, v38
    v_exp_f32 v23, v39
    v_exp_f32 v24, v40
    v_exp_f32 v25, v41
    v_exp_f32 v26, v42
    v_exp_f32 v27, v43
    v_exp_f32 v28, v44
    v_exp_f32 v29, v45
    v_exp_f32 v30, v46
    v_exp_f32 v31, v47
    v_add_f32 v16, 1.0, v16
    v_add_f32 v17, 1.0, v17
    v_add_f32 v18, 1.0, v18
    v_add_f32 v19, 1.0, v19
    v_add_f32 v20, 1.0, v20
    v_add_f32 v21, 1.0, v21
    v_add_f32 v22, 1.0, v22
    v_add_f32 v23, 1.0, v23
    v_add_f32 v24, 1.0, v24
    v_add_f32 v25, 1.0, v25
    v_add_f32 v26, 1.0, v26
    v_add_f32 v27, 1.0, v27
    v_add_f32 v28, 1.0, v28
    v_add_f32 v29, 1.0, v29
    v_add_f32 v30, 1.0, v30
    v_add_f32 v31, 1.0, v31
    v_rcp_f32 v16, v16
    v_rcp_f32 v17, v17
    v_rcp_f32 v18, v18
    v_rcp_f32 v19, v19
    v_rcp_f32 v20, v20
    v_rcp_f32 v21, v21
    v_rcp_f32 v22, v22
    v_rcp_f32 v23, v23
    v_rcp_f32 v24, v24
    v_rcp_f32 v25, v25
    v_rcp_f32 v26, v26
    v_rcp_f32 v27, v27
    v_rcp_f32 v28, v28
    v_rcp_f32 v29, v29
    v_rcp_f32 v30, v30
    v_rcp_f32 v31, v31
    v_mul_f32 v16, v32, v16
    v_mul_f32 v17, v33, v17
    v_mul_f32 v18, v34, v18
    v_mul_f32 v19, v35, v19
    v_mul_f32 v20, v36, v20
    v_mul_f32 v21, v37, v21
    v_mul_f32 v22, v38, v22
    v_mul_f32 v23, v39, v23
    v_mul_f32 v24, v40, v24
    v_mul_f32 v25, v41, v25
    v_mul_f32 v26, v42, v26
    v_mul_f32 v27, v43, v27
    v_mul_f32 v28, v44, v28
    v_mul_f32 v29, v45, v29
    v_mul_f32 v30, v46, v30
    v_mul_f32 v31, v47, v31
    v_cvt_pk_bf16_f32 v8, v16, v17
    v_cvt_pk_bf16_f32 v9, v18, v19
    v_cvt_pk_bf16_f32 v10, v20, v21
    v_cvt_pk_bf16_f32 v11, v22, v23
    v_cvt_pk_bf16_f32 v12, v24, v25
    v_cvt_pk_bf16_f32 v13, v26, v27
    v_cvt_pk_bf16_f32 v14, v28, v29
    v_cvt_pk_bf16_f32 v15, v30, v31
    v_min_u32 v8, -2, v8
    v_min_u32 v12, -2, v12
    s_cmp_eq_u32 s28, 2
    s_cbranch_scc0 L_ls_11s
    buffer_store_dwordx4 v[8:11], v0, s[60:63], s75 offen nt
    buffer_store_dwordx4 v[12:15], v0, s[60:63], s75 offen offset:1024 nt
L_ls_11b:
    s_add_u32 s75, s75, 32768
    ds_write_b32 v1, v1
    v_exp_f32 v16, v48
    v_exp_f32 v17, v49
    v_exp_f32 v18, v50
    v_exp_f32 v19, v51
    v_exp_f32 v20, v52
    v_exp_f32 v21, v53
    v_exp_f32 v22, v54
    v_exp_f32 v23, v55
    v_exp_f32 v24, v56
    v_exp_f32 v25, v57
    v_exp_f32 v26, v58
    v_exp_f32 v27, v59
    v_exp_f32 v28, v60
    v_exp_f32 v29, v61
    v_exp_f32 v30, v62
    v_exp_f32 v31, v63
    v_add_f32 v16, 1.0, v16
    v_add_f32 v17, 1.0, v17
    v_add_f32 v18, 1.0, v18
    v_add_f32 v19, 1.0, v19
    v_add_f32 v20, 1.0, v20
    v_add_f32 v21, 1.0, v21
    v_add_f32 v22, 1.0, v22
    v_add_f32 v23, 1.0, v23
    v_add_f32 v24, 1.0, v24
    v_add_f32 v25, 1.0, v25
    v_add_f32 v26, 1.0, v26
    v_add_f32 v27, 1.0, v27
    v_add_f32 v28, 1.0, v28
    v_add_f32 v29, 1.0, v29
    v_add_f32 v30, 1.0, v30
    v_add_f32 v31, 1.0, v31
    v_rcp_f32 v16, v16
    v_rcp_f32 v17, v17
    v_rcp_f32 v18, v18
    v_rcp_f32 v19, v19
    v_rcp_f32 v20, v20
    v_rcp_f32 v21, v21
    v_rcp_f32 v22, v22
    v_rcp_f32 v23, v23
    v_rcp_f32 v24, v24
    v_rcp_f32 v25, v25
    v_rcp_f32 v26, v26
    v_rcp_f32 v27, v27
    v_rcp_f32 v28, v28
    v_rcp_f32 v29, v29
    v_rcp_f32 v30, v30
    v_rcp_f32 v31, v31
    v_mul_f32 v16, v48, v16
    v_mul_f32 v17, v49, v17
    v_mul_f32 v18, v50, v18
    v_mul_f32 v19, v51, v19
    v_mul_f32 v20, v52, v20
    v_mul_f32 v21, v53, v21
    v_mul_f32 v22, v54, v22
    v_mul_f32 v23, v55, v23
    v_mul_f32 v24, v56, v24
    v_mul_f32 v25, v57, v25
    v_mul_f32 v26, v58, v26
    v_mul_f32 v27, v59, v27
    v_mul_f32 v28, v60, v28
    v_mul_f32 v29, v61, v29
    v_mul_f32 v30, v62, v30
    v_mul_f32 v31, v63, v31
    v_cvt_pk_bf16_f32 v8, v16, v17
    v_cvt_pk_bf16_f32 v9, v18, v19
    v_cvt_pk_bf16_f32 v10, v20, v21
    v_cvt_pk_bf16_f32 v11, v22, v23
    v_cvt_pk_bf16_f32 v12, v24, v25
    v_cvt_pk_bf16_f32 v13, v26, v27
    v_cvt_pk_bf16_f32 v14, v28, v29
    v_cvt_pk_bf16_f32 v15, v30, v31
    v_min_u32 v8, -2, v8
    v_min_u32 v12, -2, v12
    s_cmp_eq_u32 s28, 2
    s_cbranch_scc0 L_ls_12s
    buffer_store_dwordx4 v[8:11], v0, s[60:63], s75 offen nt
    buffer_store_dwordx4 v[12:15], v0, s[60:63], s75 offen offset:1024 nt
L_ls_12b:
    s_add_u32 s75, s75, 32768
L_f1_done:
    s_setprio 0
    s_lshl_b32 s72, s67, 7
    s_lshr_b32 s73, s66, 1
    s_lshl_b32 s73, s73, 2
    s_add_u32 s72, s72, s73
    s_add_u32 s72, s72, 8192
    s_mov_b32 exec_lo, 0xff
    s_mov_b32 exec_hi, 0x0
    s_mov_b32 s98, 0
    s_branch L_pf_13f
L_pf_13:
    s_sleep 1
L_pf_13f:
    buffer_load_dword v4, v0, s[60:63], s72 offen sc1
    s_add_u32 s98, s98, 1
    s_cmp_gt_u32 s98, 1048576
    s_cbranch_scc1 L_end
    s_waitcnt vmcnt(0)
    v_cmp_ne_u32 vcc, s70, v4
    s_cbranch_vccnz L_pf_13
    s_mov_b64 exec, -1
    v_mov_b32 v4, 132116
    v_mov_b32 v5, 1
    s_mov_b64 exec, 1
    ds_add_u32 v4, v5
    s_mov_b64 exec, -1
    s_branch L_final
L_st_s:
    s_cmp_eq_u32 s64, 4
    s_cbranch_scc1 L_s_x1
    s_mov_b32 s98, 0
L_lw_14:
    v_mov_b32 v4, 132136
    ds_read_b32 v4, v4
    s_add_u32 s98, s98, 1
    s_cmp_gt_u32 s98, 1048576
    s_cbranch_scc1 L_end
    s_sleep 1
    s_waitcnt lgkmcnt(0)
    v_readfirstlane_b32 s79, v4
    s_nop 0
    s_cmp_ge_u32 s79, 1
    s_cbranch_scc0 L_lw_14
    s_setprio 1
    s_add_u32 s76, s65, s69
    s_and_b32 s76, s76, 3
    s_and_b32 s77, s65, 0xfc
    s_add_u32 s76, s76, s77
    s_lshl_b32 s76, s76, 13
    buffer_load_dwordx4 v[32:35], v0, s[32:35], s76 offen offset:0
    buffer_load_dwordx4 v[36:39], v0, s[32:35], s76 offen offset:1024
    buffer_load_dwordx4 v[40:43], v0, s[32:35], s76 offen offset:2048
    buffer_load_dwordx4 v[44:47], v0, s[32:35], s76 offen offset:3072
    s_add_u32 s76, s76, 4096
    buffer_load_dwordx4 v[48:51], v0, s[32:35], s76 offen offset:0
    buffer_load_dwordx4 v[52:55], v0, s[32:35], s76 offen offset:1024
    buffer_load_dwordx4 v[56:59], v0, s[32:35], s76 offen offset:2048
    buffer_load_dwordx4 v[60:63], v0, s[32:35], s76 offen offset:3072
    s_setprio 0
L_s_x1:
    s_waitcnt vmcnt(0)
    v_lshlrev_b32 v64, 16, v32
    v_and_b32 v65, 0xffff0000, v32
    v_lshlrev_b32 v66, 16, v33
    v_and_b32 v67, 0xffff0000, v33
    v_lshlrev_b32 v68, 16, v34
    v_and_b32 v69, 0xffff0000, v34
    v_lshlrev_b32 v70, 16, v35
    v_and_b32 v71, 0xffff0000, v35
    v_pk_add_f32 v[20:21], v[64:65], v[66:67]
    v_pk_mul_f32 v[22:23], v[64:65], v[64:65]
    v_pk_add_f32 v[20:21], v[20:21], v[68:69]
    v_pk_fma_f32 v[22:23], v[66:67], v[66:67], v[22:23]
    v_pk_add_f32 v[20:21], v[20:21], v[70:71]
    v_pk_fma_f32 v[22:23], v[68:69], v[68:69], v[22:23]
    v_add_f32 v4, v20, v21
    v_pk_fma_f32 v[22:23], v[70:71], v[70:71], v[22:23]
    v_add_f32 v12, v22, v23
    v_lshlrev_b32 v72, 16, v36
    v_and_b32 v73, 0xffff0000, v36
    v_lshlrev_b32 v74, 16, v37
    v_and_b32 v75, 0xffff0000, v37
    v_lshlrev_b32 v76, 16, v38
    v_and_b32 v77, 0xffff0000, v38
    v_lshlrev_b32 v78, 16, v39
    v_and_b32 v79, 0xffff0000, v39
    v_pk_add_f32 v[24:25], v[72:73], v[74:75]
    v_pk_mul_f32 v[26:27], v[72:73], v[72:73]
    v_pk_add_f32 v[24:25], v[24:25], v[76:77]
    v_pk_fma_f32 v[26:27], v[74:75], v[74:75], v[26:27]
    v_pk_add_f32 v[24:25], v[24:25], v[78:79]
    v_pk_fma_f32 v[26:27], v[76:77], v[76:77], v[26:27]
    v_add_f32 v5, v24, v25
    v_pk_fma_f32 v[26:27], v[78:79], v[78:79], v[26:27]
    v_add_f32 v13, v26, v27
    v_lshlrev_b32 v80, 16, v40
    v_and_b32 v81, 0xffff0000, v40
    v_lshlrev_b32 v82, 16, v41
    v_and_b32 v83, 0xffff0000, v41
    v_lshlrev_b32 v84, 16, v42
    v_and_b32 v85, 0xffff0000, v42
    v_lshlrev_b32 v86, 16, v43
    v_and_b32 v87, 0xffff0000, v43
    v_pk_add_f32 v[20:21], v[80:81], v[82:83]
    v_pk_mul_f32 v[22:23], v[80:81], v[80:81]
    v_pk_add_f32 v[20:21], v[20:21], v[84:85]
    v_pk_fma_f32 v[22:23], v[82:83], v[82:83], v[22:23]
    v_pk_add_f32 v[20:21], v[20:21], v[86:87]
    v_pk_fma_f32 v[22:23], v[84:85], v[84:85], v[22:23]
    v_add_f32 v6, v20, v21
    v_pk_fma_f32 v[22:23], v[86:87], v[86:87], v[22:23]
    v_add_f32 v14, v22, v23
    v_lshlrev_b32 v88, 16, v44
    v_and_b32 v89, 0xffff0000, v44
    v_lshlrev_b32 v90, 16, v45
    v_and_b32 v91, 0xffff0000, v45
    v_lshlrev_b32 v92, 16, v46
    v_and_b32 v93, 0xffff0000, v46
    v_lshlrev_b32 v94, 16, v47
    v_and_b32 v95, 0xffff0000, v47
    v_pk_add_f32 v[24:25], v[88:89], v[90:91]
    v_pk_mul_f32 v[26:27], v[88:89], v[88:89]
    v_pk_add_f32 v[24:25], v[24:25], v[92:93]
    v_pk_fma_f32 v[26:27], v[90:91], v[90:91], v[26:27]
    v_pk_add_f32 v[24:25], v[24:25], v[94:95]
    v_pk_fma_f32 v[26:27], v[92:93], v[92:93], v[26:27]
    v_add_f32 v7, v24, v25
    v_pk_fma_f32 v[26:27], v[94:95], v[94:95], v[26:27]
    v_add_f32 v15, v26, v27
    v_lshlrev_b32 v96, 16, v48
    v_and_b32 v97, 0xffff0000, v48
    v_lshlrev_b32 v98, 16, v49
    v_and_b32 v99, 0xffff0000, v49
    v_lshlrev_b32 v100, 16, v50
    v_and_b32 v101, 0xffff0000, v50
    v_lshlrev_b32 v102, 16, v51
    v_and_b32 v103, 0xffff0000, v51
    v_pk_add_f32 v[20:21], v[96:97], v[98:99]
    v_pk_mul_f32 v[22:23], v[96:97], v[96:97]
    v_pk_add_f32 v[20:21], v[20:21], v[100:101]
    v_pk_fma_f32 v[22:23], v[98:99], v[98:99], v[22:23]
    v_pk_add_f32 v[20:21], v[20:21], v[102:103]
    v_pk_fma_f32 v[22:23], v[100:101], v[100:101], v[22:23]
    v_add_f32 v8, v20, v21
    v_pk_fma_f32 v[22:23], v[102:103], v[102:103], v[22:23]
    v_add_f32 v16, v22, v23
    v_lshlrev_b32 v104, 16, v52
    v_and_b32 v105, 0xffff0000, v52
    v_lshlrev_b32 v106, 16, v53
    v_and_b32 v107, 0xffff0000, v53
    v_lshlrev_b32 v108, 16, v54
    v_and_b32 v109, 0xffff0000, v54
    v_lshlrev_b32 v110, 16, v55
    v_and_b32 v111, 0xffff0000, v55
    v_pk_add_f32 v[24:25], v[104:105], v[106:107]
    v_pk_mul_f32 v[26:27], v[104:105], v[104:105]
    v_pk_add_f32 v[24:25], v[24:25], v[108:109]
    v_pk_fma_f32 v[26:27], v[106:107], v[106:107], v[26:27]
    v_pk_add_f32 v[24:25], v[24:25], v[110:111]
    v_pk_fma_f32 v[26:27], v[108:109], v[108:109], v[26:27]
    v_add_f32 v9, v24, v25
    v_pk_fma_f32 v[26:27], v[110:111], v[110:111], v[26:27]
    v_add_f32 v17, v26, v27
    v_lshlrev_b32 v112, 16, v56
    v_and_b32 v113, 0xffff0000, v56
    v_lshlrev_b32 v114, 16, v57
    v_and_b32 v115, 0xffff0000, v57
    v_lshlrev_b32 v116, 16, v58
    v_and_b32 v117, 0xffff0000, v58
    v_lshlrev_b32 v118, 16, v59
    v_and_b32 v119, 0xffff0000, v59
    v_pk_add_f32 v[20:21], v[112:113], v[114:115]
    v_pk_mul_f32 v[22:23], v[112:113], v[112:113]
    v_pk_add_f32 v[20:21], v[20:21], v[116:117]
    v_pk_fma_f32 v[22:23], v[114:115], v[114:115], v[22:23]
    v_pk_add_f32 v[20:21], v[20:21], v[118:119]
    v_pk_fma_f32 v[22:23], v[116:117], v[116:117], v[22:23]
    v_add_f32 v10, v20, v21
    v_pk_fma_f32 v[22:23], v[118:119], v[118:119], v[22:23]
    v_add_f32 v18, v22, v23
    v_lshlrev_b32 v120, 16, v60
    v_and_b32 v121, 0xffff0000, v60
    v_lshlrev_b32 v122, 16, v61
    v_and_b32 v123, 0xffff0000, v61
    v_lshlrev_b32 v124, 16, v62
    v_and_b32 v125, 0xffff0000, v62
    v_lshlrev_b32 v126, 16, v63
    v_and_b32 v127, 0xffff0000, v63
    v_pk_add_f32 v[24:25], v[120:121], v[122:123]
    v_pk_mul_f32 v[26:27], v[120:121], v[120:121]
    v_pk_add_f32 v[24:25], v[24:25], v[124:125]
    v_pk_fma_f32 v[26:27], v[122:123], v[122:123], v[26:27]
    v_pk_add_f32 v[24:25], v[24:25], v[126:127]
    v_pk_fma_f32 v[26:27], v[124:125], v[124:125], v[26:27]
    v_add_f32 v11, v24, v25
    v_pk_fma_f32 v[26:27], v[126:127], v[126:127], v[26:27]
    v_add_f32 v19, v26, v27
    v_permlane32_swap_b32 v4, v8
    v_permlane32_swap_b32 v5, v9
    v_permlane32_swap_b32 v6, v10
    v_permlane32_swap_b32 v7, v11
    v_permlane32_swap_b32 v12, v16
    v_permlane32_swap_b32 v13, v17
    v_permlane32_swap_b32 v14, v18
    v_permlane32_swap_b32 v15, v19
    v_pk_add_f32 v[4:5], v[4:5], v[8:9]
    v_pk_add_f32 v[6:7], v[6:7], v[10:11]
    v_pk_add_f32 v[12:13], v[12:13], v[16:17]
    v_pk_add_f32 v[14:15], v[14:15], v[18:19]
    v_permlane16_swap_b32 v4, v6
    v_permlane16_swap_b32 v5, v7
    v_permlane16_swap_b32 v12, v14
    v_permlane16_swap_b32 v13, v15
    v_pk_add_f32 v[4:5], v[4:5], v[6:7]
    v_pk_add_f32 v[12:13], v[12:13], v[14:15]
    v_mov_b32 v20, 0x3b000000
    v_mov_b32 v21, 0x3727c5ac
    v_add_f32_dpp v4, v4, v4 row_ror:8 row_mask:0xf bank_mask:0xf
    v_add_f32_dpp v5, v5, v5 row_ror:8 row_mask:0xf bank_mask:0xf
    v_add_f32_dpp v12, v12, v12 row_ror:8 row_mask:0xf bank_mask:0xf
    v_add_f32_dpp v13, v13, v13 row_ror:8 row_mask:0xf bank_mask:0xf
    v_add_f32_dpp v4, v4, v4 row_ror:4 row_mask:0xf bank_mask:0xf
    v_add_f32_dpp v5, v5, v5 row_ror:4 row_mask:0xf bank_mask:0xf
    v_add_f32_dpp v12, v12, v12 row_ror:4 row_mask:0xf bank_mask:0xf
    v_add_f32_dpp v13, v13, v13 row_ror:4 row_mask:0xf bank_mask:0xf
    v_add_f32_dpp v4, v4, v4 row_ror:2 row_mask:0xf bank_mask:0xf
    v_add_f32_dpp v5, v5, v5 row_ror:2 row_mask:0xf bank_mask:0xf
    v_add_f32_dpp v12, v12, v12 row_ror:2 row_mask:0xf bank_mask:0xf
    v_add_f32_dpp v13, v13, v13 row_ror:2 row_mask:0xf bank_mask:0xf
    v_add_f32_dpp v4, v4, v4 row_ror:1 row_mask:0xf bank_mask:0xf
    v_add_f32_dpp v5, v5, v5 row_ror:1 row_mask:0xf bank_mask:0xf
    v_add_f32_dpp v12, v12, v12 row_ror:1 row_mask:0xf bank_mask:0xf
    v_add_f32_dpp v13, v13, v13 row_ror:1 row_mask:0xf bank_mask:0xf
    v_mul_f32 v4, v20, v4
    v_mul_f32 v5, v20, v5
    v_fma_f32 v12, v12, v20, v21
    v_fma_f32 v13, v13, v20, v21
    v_fma_f32 v12, -v4, v4, v12
    v_fma_f32 v13, -v5, v5, v13
    v_max_f32 v12, v21, v12
    v_max_f32 v13, v21, v13
    v_rsq_f32 v8, v12
    v_rsq_f32 v10, v13
    v_mul_f32_e64 v9, v4, -v8
    v_mul_f32_e64 v11, v5, -v10
    s_cmp_eq_u32 s64, 4
    s_cbranch_scc0 L_s_nost
    v_lshrrev_b32 v4, 8, v0
    v_lshlrev_b32 v4, 4, v4
    v_add_u32 v4, 132416, v4
    ds_write_b128 v4, v[8:11]
    v_mov_b32 v4, 132156
    v_mov_b32 v5, 1
    s_mov_b64 exec, 1
    ds_add_u32 v4, v5
    s_mov_b64 exec, -1
L_s_nost:
    v_readlane_b32 s80, v8, 0
    v_readlane_b32 s81, v9, 0
    v_readlane_b32 s82, v10, 0
    v_readlane_b32 s83, v11, 0
    v_readlane_b32 s84, v8, 16
    v_readlane_b32 s85, v9, 16
    v_readlane_b32 s86, v10, 16
    v_readlane_b32 s87, v11, 16
    v_readlane_b32 s88, v8, 32
    v_readlane_b32 s89, v9, 32
    v_readlane_b32 s90, v10, 32
    v_readlane_b32 s91, v11, 32
    v_readlane_b32 s92, v8, 48
    v_readlane_b32 s93, v9, 48
    v_readlane_b32 s94, v10, 48
    v_readlane_b32 s95, v11, 48
    v_pk_fma_f32 v[64:65], v[64:65], s[80:81], s[80:81] op_sel:[0,0,1] op_sel_hi:[1,0,1]
    v_pk_fma_f32 v[66:67], v[66:67], s[80:81], s[80:81] op_sel:[0,0,1] op_sel_hi:[1,0,1]
    v_pk_fma_f32 v[68:69], v[68:69], s[80:81], s[80:81] op_sel:[0,0,1] op_sel_hi:[1,0,1]
    v_pk_fma_f32 v[70:71], v[70:71], s[80:81], s[80:81] op_sel:[0,0,1] op_sel_hi:[1,0,1]
    v_pk_fma_f32 v[72:73], v[72:73], s[82:83], s[82:83] op_sel:[0,0,1] op_sel_hi:[1,0,1]
    v_pk_fma_f32 v[74:75], v[74:75], s[82:83], s[82:83] op_sel:[0,0,1] op_sel_hi:[1,0,1]
    v_pk_fma_f32 v[76:77], v[76:77], s[82:83], s[82:83] op_sel:[0,0,1] op_sel_hi:[1,0,1]
    v_pk_fma_f32 v[78:79], v[78:79], s[82:83], s[82:83] op_sel:[0,0,1] op_sel_hi:[1,0,1]
    v_pk_fma_f32 v[80:81], v[80:81], s[84:85], s[84:85] op_sel:[0,0,1] op_sel_hi:[1,0,1]
    v_pk_fma_f32 v[82:83], v[82:83], s[84:85], s[84:85] op_sel:[0,0,1] op_sel_hi:[1,0,1]
    v_pk_fma_f32 v[84:85], v[84:85], s[84:85], s[84:85] op_sel:[0,0,1] op_sel_hi:[1,0,1]
    v_pk_fma_f32 v[86:87], v[86:87], s[84:85], s[84:85] op_sel:[0,0,1] op_sel_hi:[1,0,1]
    v_pk_fma_f32 v[88:89], v[88:89], s[86:87], s[86:87] op_sel:[0,0,1] op_sel_hi:[1,0,1]
    v_pk_fma_f32 v[90:91], v[90:91], s[86:87], s[86:87] op_sel:[0,0,1] op_sel_hi:[1,0,1]
    v_pk_fma_f32 v[92:93], v[92:93], s[86:87], s[86:87] op_sel:[0,0,1] op_sel_hi:[1,0,1]
    v_pk_fma_f32 v[94:95], v[94:95], s[86:87], s[86:87] op_sel:[0,0,1] op_sel_hi:[1,0,1]
    v_pk_fma_f32 v[96:97], v[96:97], s[88:89], s[88:89] op_sel:[0,0,1] op_sel_hi:[1,0,1]
    v_pk_fma_f32 v[98:99], v[98:99], s[88:89], s[88:89] op_sel:[0,0,1] op_sel_hi:[1,0,1]
    v_pk_fma_f32 v[100:101], v[100:101], s[88:89], s[88:89] op_sel:[0,0,1] op_sel_hi:[1,0,1]
    v_pk_fma_f32 v[102:103], v[102:103], s[88:89], s[88:89] op_sel:[0,0,1] op_sel_hi:[1,0,1]
    v_pk_fma_f32 v[104:105], v[104:105], s[90:91], s[90:91] op_sel:[0,0,1] op_sel_hi:[1,0,1]
    v_pk_fma_f32 v[106:107], v[106:107], s[90:91], s[90:91] op_sel:[0,0,1] op_sel_hi:[1,0,1]
    v_pk_fma_f32 v[108:109], v[108:109], s[90:91], s[90:91] op_sel:[0,0,1] op_sel_hi:[1,0,1]
    v_pk_fma_f32 v[110:111], v[110:111], s[90:91], s[90:91] op_sel:[0,0,1] op_sel_hi:[1,0,1]
    v_pk_fma_f32 v[112:113], v[112:113], s[92:93], s[92:93] op_sel:[0,0,1] op_sel_hi:[1,0,1]
    v_pk_fma_f32 v[114:115], v[114:115], s[92:93], s[92:93] op_sel:[0,0,1] op_sel_hi:[1,0,1]
    v_pk_fma_f32 v[116:117], v[116:117], s[92:93], s[92:93] op_sel:[0,0,1] op_sel_hi:[1,0,1]
    v_pk_fma_f32 v[118:119], v[118:119], s[92:93], s[92:93] op_sel:[0,0,1] op_sel_hi:[1,0,1]
    v_pk_fma_f32 v[120:121], v[120:121], s[94:95], s[94:95] op_sel:[0,0,1] op_sel_hi:[1,0,1]
    v_pk_fma_f32 v[122:123], v[122:123], s[94:95], s[94:95] op_sel:[0,0,1] op_sel_hi:[1,0,1]
    v_pk_fma_f32 v[124:125], v[124:125], s[94:95], s[94:95] op_sel:[0,0,1] op_sel_hi:[1,0,1]
    v_pk_fma_f32 v[126:127], v[126:127], s[94:95], s[94:95] op_sel:[0,0,1] op_sel_hi:[1,0,1]
    v_lshrrev_b32 v5, 9, v0
    v_bfe_u32 v4, v0, 4, 5
    v_mul_u32_u24 v28, 1040, v4
    v_lshl_add_u32 v28, v5, 4, v28
    v_add_u32 v28, 65536, v28
    v_lshrrev_b32 v6, 3, v4
    v_add_u32 v7, s1, v6
    v_and_b32 v7, 3, v7
    v_lshlrev_b32 v7, 13, v7
    s_lshr_b32 s73, s69, 1
    v_lshlrev_b32 v6, 1, v6
    v_sub_u32 v6, s73, v6
    v_and_b32 v6, 7, v6
    v_lshlrev_b32 v6, 10, v6
    v_and_b32 v4, 0x70, v0
    v_lshl_add_u32 v4, v5, 9, v4
    s_and_b32 s72, s69, 1
    s_lshl_b32 s72, s72, 8
    v_add3_u32 v6, v6, v4, s72
    v_add_u32 v30, v7, v6
    v_add_u32 v31, 133120, v6
    v_bfe_u32 v4, v0, 4, 3
    s_lshl_b32 s72, s69, 3
    v_add_u32 v5, s72, v4
    v_lshlrev_b32 v6, 2, v5
    v_add_u32 v21, 149504, v6
    v_bfe_u32 v16, v0, 7, 2
    v_lshl_add_u32 v29, v16, 7, v21
    v_lshlrev_b32 v5, 4, v5
    v_lshrrev_b32 v6, 9, v0
    v_lshl_add_u32 v5, v6, 10, v5
    v_bfe_u32 v7, v0, 8, 1
    v_lshl_add_u32 v5, v7, 9, v5
    v_bfe_u32 v7, v0, 7, 1
    v_lshl_add_u32 v5, v7, 3, v5
    v_add_u32 v20, 141312, v5
    v_lshlrev_b32 v5, 7, v6
    v_lshl_add_u32 v5, v4, 4, v5
    v_lshl_add_u32 v5, v16, 2, v5
    s_lshl_b32 s72, s69, 8
    s_add_u32 s72, s72, 131072
    v_add_u32 v22, s72, v5
    v_lshrrev_b32 v5, 8, v0
    v_lshlrev_b32 v6, 7, v5
    v_lshl_add_u32 v6, v4, 4, v6
    v_add_u32 v6, 131072, v6
    v_cmp_eq_u32 vcc, 0, v7
    v_mov_b32 v16, 132096
    v_lshlrev_b32 v17, 8, v7
    v_cndmask_b32 v23, v16, v6, vcc
    v_cndmask_b32 v24, v6, v16, vcc
    v_lshl_add_u32 v17, v5, 4, v17
    s_lshl_b32 s72, s69, 9
    v_add_u32 v25, s72, v17
    v_add_u32 v25, 153600, v25
    s_waitcnt lgkmcnt(0)
    s_mul_i32 s70, s71, 0x9e3779b1
    s_add_u32 s70, s70, 0x7f4a7c15
    v_lshlrev_b32 v1, 1, v0
    v_add_u32 v1, 157696, v1
    s_mul_i32 s72, s69, 8320
    s_add_u32 s72, s72, 65536
    v_add_u32 v3, s72, v0
    v_lshrrev_b32 v4, 9, v0
    v_bfe_u32 v5, v0, 6, 2
    v_lshl_add_u32 v4, v4, 3, v5
    v_lshlrev_b32 v4, 8, v4
    v_xor_b32 v5, s69, v5
    v_lshl_add_u32 v4, v5, 6, v4
    v_bfe_u32 v5, v0, 8, 1
    v_lshl_add_u32 v4, v5, 5, v4
    v_bfe_u32 v5, v0, 4, 2
    v_lshl_add_u32 v27, v5, 3, v4
    s_mov_b32 s98, 0
L_lw_15:
    v_mov_b32 v26, 132152
    ds_read_b32 v26, v26
    s_add_u32 s98, s98, 1
    s_cmp_gt_u32 s98, 1048576
    s_cbranch_scc1 L_end
    s_sleep 1
    s_waitcnt lgkmcnt(0)
    v_readfirstlane_b32 s79, v26
    s_nop 0
    s_cmp_ge_u32 s79, 4
    s_cbranch_scc0 L_lw_15
    ds_read_b64_tr_b16 v[128:129], v27 offset:0
    ds_read_b64_tr_b16 v[130:131], v27 offset:1024
    ds_read_b64_tr_b16 v[132:133], v27 offset:4096
    ds_read_b64_tr_b16 v[134:135], v27 offset:5120
    ds_read_b64_tr_b16 v[136:137], v27 offset:8192
    ds_read_b64_tr_b16 v[138:139], v27 offset:9216
    ds_read_b64_tr_b16 v[140:141], v27 offset:12288
    ds_read_b64_tr_b16 v[142:143], v27 offset:13312
    ds_read_b64_tr_b16 v[144:145], v27 offset:16384
    ds_read_b64_tr_b16 v[146:147], v27 offset:17408
    ds_read_b64_tr_b16 v[148:149], v27 offset:20480
    ds_read_b64_tr_b16 v[150:151], v27 offset:21504
    ds_read_b64_tr_b16 v[152:153], v27 offset:24576
    ds_read_b64_tr_b16 v[154:155], v27 offset:25600
    ds_read_b64_tr_b16 v[156:157], v27 offset:28672
    ds_read_b64_tr_b16 v[158:159], v27 offset:29696
    ds_read_b64_tr_b16 v[160:161], v27 offset:32768
    ds_read_b64_tr_b16 v[162:163], v27 offset:33792
    ds_read_b64_tr_b16 v[164:165], v27 offset:36864
    ds_read_b64_tr_b16 v[166:167], v27 offset:37888
    ds_read_b64_tr_b16 v[168:169], v27 offset:40960
    ds_read_b64_tr_b16 v[170:171], v27 offset:41984
    ds_read_b64_tr_b16 v[172:173], v27 offset:45056
    ds_read_b64_tr_b16 v[174:175], v27 offset:46080
    ds_read_b64_tr_b16 v[176:177], v27 offset:49152
    ds_read_b64_tr_b16 v[178:179], v27 offset:50176
    ds_read_b64_tr_b16 v[180:181], v27 offset:53248
    ds_read_b64_tr_b16 v[182:183], v27 offset:54272
    ds_read_b64_tr_b16 v[184:185], v27 offset:57344
    ds_read_b64_tr_b16 v[186:187], v27 offset:58368
    ds_read_b64_tr_b16 v[188:189], v27 offset:61440
    ds_read_b64_tr_b16 v[190:191], v27 offset:62464
    v_mov_b32 v4, 132132
    v_mov_b32 v5, 1
    s_mov_b64 exec, 1
    ds_add_u32 v4, v5
    s_mov_b64 exec, -1
    v_lshrrev_b32 v4, 8, v0
    v_lshlrev_b32 v2, 10, v4
    v_lshlrev_b32 v4, 6, v4
    v_xor_b32 v4, v4, v0
    v_and_b32 v4, 0xf0, v4
    v_add_u32 v2, v2, v4
    s_lshl_b32 s89, s69, 14
    s_lshl_b32 s88, s1, 8
    s_lshl_b32 s72, s69, 16
    s_add_u32 s88, s88, s72
    s_add_u32 s88, s88, 262144
    s_mov_b32 s98, 0
L_lw_16:
    v_mov_b32 v26, 132132
    ds_read_b32 v26, v26
    s_add_u32 s98, s98, 1
    s_cmp_gt_u32 s98, 1048576
    s_cbranch_scc1 L_end
    s_waitcnt lgkmcnt(0)
    v_readfirstlane_b32 s79, v26
    s_nop 0
    s_cmp_ge_u32 s79, 4
    s_cbranch_scc0 L_lw_16
    s_mov_b32 m0, s89
    s_mov_b32 s72, 2
L_wq_17:
    buffer_load_dwordx4 v2, s[36:39], s88 offen lds
    s_add_u32 m0, m0, 1024
    s_add_u32 s88, s88, 4096
    buffer_load_dwordx4 v2, s[36:39], s88 offen lds
    s_add_u32 m0, m0, 1024
    s_add_u32 s88, s88, 4096
    buffer_load_dwordx4 v2, s[36:39], s88 offen lds
    s_add_u32 m0, m0, 1024
    s_add_u32 s88, s88, 4096
    buffer_load_dwordx4 v2, s[36:39], s88 offen lds
    s_add_u32 m0, m0, 1024
    s_add_u32 s88, s88, 4096
    buffer_load_dwordx4 v2, s[36:39], s88 offen lds
    s_add_u32 m0, m0, 1024
    s_add_u32 s88, s88, 4096
    buffer_load_dwordx4 v2, s[36:39], s88 offen lds
    s_add_u32 m0, m0, 1024
    s_add_u32 s88, s88, 4096
    buffer_load_dwordx4 v2, s[36:39], s88 offen lds
    s_add_u32 m0, m0, 1024
    s_add_u32 s88, s88, 4096
    buffer_load_dwordx4 v2, s[36:39], s88 offen lds
    s_add_u32 m0, m0, 1024
    s_add_u32 s88, s88, 4096
    s_sub_u32 s72, s72, 1
    s_cmp_lg_u32 s72, 0
    s_cbranch_scc1 L_wq_17
    s_add_u32 s88, s88, 131072
    s_mov_b32 s98, 0
L_lw_18:
    v_mov_b32 v26, 132140
    ds_read_b32 v26, v26
    s_add_u32 s98, s98, 1
    s_cmp_gt_u32 s98, 1048576
    s_cbranch_scc1 L_end
    s_sleep 1
    s_waitcnt lgkmcnt(0)
    v_readfirstlane_b32 s79, v26
    s_nop 0
    s_cmp_ge_u32 s79, 4
    s_cbranch_scc0 L_lw_18
    ds_read_b128 v[12:15], v1 offset:2048
    ds_read_b128 v[4:7], v1
    ds_read_b128 v[16:19], v1 offset:2064
    ds_read_b128 v[8:11], v1 offset:16
    s_cmp_eq_u32 s64, 4
    s_waitcnt lgkmcnt(0)
    s_cbranch_scc1 L_s_h8
.p2align 3
L_s_hrows:
    v_fma_f32 v192, v64, v12, v4
    v_fma_f32 v193, v65, v13, v5
    v_fma_f32 v194, v66, v14, v6
    v_fma_f32 v195, v67, v15, v7
    v_fma_f32 v196, v68, v16, v8
    v_fma_f32 v197, v69, v17, v9
    v_fma_f32 v198, v70, v18, v10
    v_fma_f32 v199, v71, v19, v11
    v_cvt_pk_bf16_f32 v32, v192, v193
    v_cvt_pk_bf16_f32 v33, v194, v195
    v_cvt_pk_bf16_f32 v34, v196, v197
    v_cvt_pk_bf16_f32 v35, v198, v199
    ds_write_b128 v3, v[32:35] offset:0
    v_fma_f32 v200, v72, v12, v4
    v_fma_f32 v201, v73, v13, v5
    v_fma_f32 v202, v74, v14, v6
    v_fma_f32 v203, v75, v15, v7
    v_fma_f32 v204, v76, v16, v8
    v_fma_f32 v205, v77, v17, v9
    v_fma_f32 v206, v78, v18, v10
    v_fma_f32 v207, v79, v19, v11
    v_cvt_pk_bf16_f32 v36, v200, v201
    v_cvt_pk_bf16_f32 v37, v202, v203
    v_cvt_pk_bf16_f32 v38, v204, v205
    v_cvt_pk_bf16_f32 v39, v206, v207
    ds_write_b128 v3, v[36:39] offset:1040
    v_fma_f32 v208, v80, v12, v4
    v_fma_f32 v209, v81, v13, v5
    v_fma_f32 v210, v82, v14, v6
    v_fma_f32 v211, v83, v15, v7
    v_fma_f32 v212, v84, v16, v8
    v_fma_f32 v213, v85, v17, v9
    v_fma_f32 v214, v86, v18, v10
    v_fma_f32 v215, v87, v19, v11
    v_cvt_pk_bf16_f32 v40, v208, v209
    v_cvt_pk_bf16_f32 v41, v210, v211
    v_cvt_pk_bf16_f32 v42, v212, v213
    v_cvt_pk_bf16_f32 v43, v214, v215
    ds_write_b128 v3, v[40:43] offset:2080
    v_fma_f32 v216, v88, v12, v4
    v_fma_f32 v217, v89, v13, v5
    v_fma_f32 v218, v90, v14, v6
    v_fma_f32 v219, v91, v15, v7
    v_fma_f32 v220, v92, v16, v8
    v_fma_f32 v221, v93, v17, v9
    v_fma_f32 v222, v94, v18, v10
    v_fma_f32 v223, v95, v19, v11
    v_cvt_pk_bf16_f32 v44, v216, v217
    v_cvt_pk_bf16_f32 v45, v218, v219
    v_cvt_pk_bf16_f32 v46, v220, v221
    v_cvt_pk_bf16_f32 v47, v222, v223
    ds_write_b128 v3, v[44:47] offset:3120
    v_fma_f32 v224, v96, v12, v4
    v_fma_f32 v225, v97, v13, v5
    v_fma_f32 v226, v98, v14, v6
    v_fma_f32 v227, v99, v15, v7
    v_fma_f32 v228, v100, v16, v8
    v_fma_f32 v229, v101, v17, v9
    v_fma_f32 v230, v102, v18, v10
    v_fma_f32 v231, v103, v19, v11
    v_cvt_pk_bf16_f32 v48, v224, v225
    v_cvt_pk_bf16_f32 v49, v226, v227
    v_cvt_pk_bf16_f32 v50, v228, v229
    v_cvt_pk_bf16_f32 v51, v230, v231
    ds_write_b128 v3, v[48:51] offset:4160
    v_fma_f32 v232, v104, v12, v4
    v_fma_f32 v233, v105, v13, v5
    v_fma_f32 v234, v106, v14, v6
    v_fma_f32 v235, v107, v15, v7
    v_fma_f32 v236, v108, v16, v8
    v_fma_f32 v237, v109, v17, v9
    v_fma_f32 v238, v110, v18, v10
    v_fma_f32 v239, v111, v19, v11
    v_cvt_pk_bf16_f32 v52, v232, v233
    v_cvt_pk_bf16_f32 v53, v234, v235
    v_cvt_pk_bf16_f32 v54, v236, v237
    v_cvt_pk_bf16_f32 v55, v238, v239
    ds_write_b128 v3, v[52:55] offset:5200
    v_fma_f32 v240, v112, v12, v4
    v_fma_f32 v241, v113, v13, v5
    v_fma_f32 v242, v114, v14, v6
    v_fma_f32 v243, v115, v15, v7
    v_fma_f32 v244, v116, v16, v8
    v_fma_f32 v245, v117, v17, v9
    v_fma_f32 v246, v118, v18, v10
    v_fma_f32 v247, v119, v19, v11
    v_cvt_pk_bf16_f32 v56, v240, v241
    v_cvt_pk_bf16_f32 v57, v242, v243
    v_cvt_pk_bf16_f32 v58, v244, v245
    v_cvt_pk_bf16_f32 v59, v246, v247
    ds_write_b128 v3, v[56:59] offset:6240
    v_fma_f32 v248, v120, v12, v4
    v_fma_f32 v249, v121, v13, v5
    v_fma_f32 v250, v122, v14, v6
    v_fma_f32 v251, v123, v15, v7
    v_fma_f32 v252, v124, v16, v8
    v_fma_f32 v253, v125, v17, v9
    v_fma_f32 v254, v126, v18, v10
    v_fma_f32 v255, v127, v19, v11
    v_cvt_pk_bf16_f32 v60, v248, v249
    v_cvt_pk_bf16_f32 v61, v250, v251
    v_cvt_pk_bf16_f32 v62, v252, v253
    v_cvt_pk_bf16_f32 v63, v254, v255
    ds_write_b128 v3, v[60:63] offset:7280
L_s_h8:
    s_waitcnt vmcnt(0)
    v_mov_b32 v4, 132148
    v_mov_b32 v5, 1
    s_mov_b64 exec, 1
    ds_add_u32 v4, v5
    s_mov_b64 exec, -1
    s_mov_b32 s98, 0
L_lw_19:
    v_mov_b32 v26, 132148
    ds_read_b32 v26, v26
    s_add_u32 s98, s98, 1
    s_cmp_gt_u32 s98, 1048576
    s_cbranch_scc1 L_end
    s_waitcnt lgkmcnt(0)
    v_readfirstlane_b32 s79, v26
    s_nop 0
    s_cmp_ge_u32 s79, 4
    s_cbranch_scc0 L_lw_19
    s_setprio 2
    ds_read_b128 v[64:67], v28 offset:0
    ds_read_b128 v[68:71], v28 offset:32
    ds_read_b128 v[72:75], v28 offset:64
    ds_read_b128 v[76:79], v28 offset:96
    ds_read_b128 v[80:83], v28 offset:128
    ds_read_b128 v[84:87], v28 offset:160
    ds_read_b64_tr_b16 v[192:193], v27 offset:0
    ds_read_b64_tr_b16 v[194:195], v27 offset:1024
    s_waitcnt lgkmcnt(7)
    v_mfma_f32_32x32x16_bf16 v[32:47], v[128:131], v[64:67], 0
    ds_read_b128 v[88:91], v28 offset:192
    ds_read_b64_tr_b16 v[196:197], v27 offset:4096
    ds_read_b64_tr_b16 v[198:199], v27 offset:5120
    s_waitcnt lgkmcnt(9)
    v_mfma_f32_32x32x16_bf16 v[32:47], v[132:135], v[68:71], v[32:47]
    ds_read_b128 v[92:95], v28 offset:224
    ds_read_b64_tr_b16 v[200:201], v27 offset:8192
    ds_read_b64_tr_b16 v[202:203], v27 offset:9216
    s_waitcnt lgkmcnt(11)
    v_mfma_f32_32x32x16_bf16 v[32:47], v[136:139], v[72:75], v[32:47]
    ds_read_b128 v[96:99], v28 offset:256
    ds_read_b64_tr_b16 v[204:205], v27 offset:12288
    ds_read_b64_tr_b16 v[206:207], v27 offset:13312
    s_waitcnt lgkmcnt(13)
    v_mfma_f32_32x32x16_bf16 v[32:47], v[140:143], v[76:79], v[32:47]
    ds_read_b128 v[100:103], v28 offset:288
    ds_read_b64_tr_b16 v[208:209], v27 offset:16384
    ds_read_b64_tr_b16 v[210:211], v27 offset:17408
    s_waitcnt lgkmcnt(14)
    v_mfma_f32_32x32x16_bf16 v[32:47], v[144:147], v[80:83], v[32:47]
    ds_read_b128 v[104:107], v28 offset:320
    ds_read_b64_tr_b16 v[212:213], v27 offset:20480
    ds_read_b64_tr_b16 v[214:215], v27 offset:21504
    s_waitcnt lgkmcnt(14)
    v_mfma_f32_32x32x16_bf16 v[32:47], v[148:151], v[84:87], v[32:47]
    ds_read_b128 v[108:111], v28 offset:352
    ds_read_b64_tr_b16 v[216:217], v27 offset:24576
    ds_read_b64_tr_b16 v[218:219], v27 offset:25600
    s_waitcnt lgkmcnt(14)
    v_mfma_f32_32x32x16_bf16 v[32:47], v[152:155], v[88:91], v[32:47]
    ds_read_b128 v[112:115], v28 offset:384
    ds_read_b64_tr_b16 v[220:221], v27 offset:28672
    ds_read_b64_tr_b16 v[222:223], v27 offset:29696
    s_waitcnt lgkmcnt(14)
    v_mfma_f32_32x32x16_bf16 v[32:47], v[156:159], v[92:95], v[32:47]
    ds_read_b128 v[116:119], v28 offset:416
    ds_read_b64_tr_b16 v[224:225], v27 offset:32768
    ds_read_b64_tr_b16 v[226:227], v27 offset:33792
    s_waitcnt lgkmcnt(14)
    v_mfma_f32_32x32x16_bf16 v[32:47], v[160:163], v[96:99], v[32:47]
    ds_read_b128 v[120:123], v28 offset:448
    ds_read_b64_tr_b16 v[228:229], v27 offset:36864
    ds_read_b64_tr_b16 v[230:231], v27 offset:37888
    s_waitcnt lgkmcnt(14)
    v_mfma_f32_32x32x16_bf16 v[32:47], v[164:167], v[100:103], v[32:47]
    ds_read_b128 v[124:127], v28 offset:480
    ds_read_b64_tr_b16 v[232:233], v27 offset:40960
    ds_read_b64_tr_b16 v[234:235], v27 offset:41984
    s_waitcnt lgkmcnt(14)
    v_mfma_f32_32x32x16_bf16 v[32:47], v[168:171], v[104:107], v[32:47]
    ds_read_b128 v[64:67], v28 offset:512
    ds_read_b64_tr_b16 v[236:237], v27 offset:45056
    ds_read_b64_tr_b16 v[238:239], v27 offset:46080
    s_waitcnt lgkmcnt(14)
    v_mfma_f32_32x32x16_bf16 v[32:47], v[172:175], v[108:111], v[32:47]
    ds_read_b128 v[68:71], v28 offset:544
    ds_read_b64_tr_b16 v[240:241], v27 offset:49152
    ds_read_b64_tr_b16 v[242:243], v27 offset:50176
    s_waitcnt lgkmcnt(14)
    v_mfma_f32_32x32x16_bf16 v[32:47], v[176:179], v[112:115], v[32:47]
    ds_read_b128 v[72:75], v28 offset:576
    ds_read_b64_tr_b16 v[244:245], v27 offset:53248
    ds_read_b64_tr_b16 v[246:247], v27 offset:54272
    s_waitcnt lgkmcnt(14)
    v_mfma_f32_32x32x16_bf16 v[32:47], v[180:183], v[116:119], v[32:47]
    ds_read_b128 v[76:79], v28 offset:608
    ds_read_b64_tr_b16 v[248:249], v27 offset:57344
    ds_read_b64_tr_b16 v[250:251], v27 offset:58368
    s_waitcnt lgkmcnt(14)
    v_mfma_f32_32x32x16_bf16 v[32:47], v[184:187], v[120:123], v[32:47]
    ds_read_b128 v[80:83], v28 offset:640
    ds_read_b64_tr_b16 v[252:253], v27 offset:61440
    ds_read_b64_tr_b16 v[254:255], v27 offset:62464
    s_waitcnt lgkmcnt(14)
    v_mfma_f32_32x32x16_bf16 v[32:47], v[188:191], v[124:127], v[32:47]
    ds_read_b128 v[84:87], v28 offset:672
    s_waitcnt lgkmcnt(14)
    v_mfma_f32_32x32x16_bf16 v[32:47], v[192:195], v[64:67], v[32:47]
    ds_read_b128 v[88:91], v28 offset:704
    s_waitcnt lgkmcnt(13)
    v_mfma_f32_32x32x16_bf16 v[32:47], v[196:199], v[68:71], v[32:47]
    ds_read_b128 v[92:95], v28 offset:736
    s_waitcnt lgkmcnt(11)
    v_mfma_f32_32x32x16_bf16 v[32:47], v[200:203], v[72:75], v[32:47]
    ds_read_b128 v[96:99], v28 offset:768
    s_waitcnt lgkmcnt(9)
    v_mfma_f32_32x32x16_bf16 v[32:47], v[204:207], v[76:79], v[32:47]
    ds_read_b128 v[100:103], v28 offset:800
    s_waitcnt lgkmcnt(7)
    v_mfma_f32_32x32x16_bf16 v[32:47], v[208:211], v[80:83], v[32:47]
    ds_read_b128 v[104:107], v28 offset:832
    s_waitcnt lgkmcnt(5)
    v_mfma_f32_32x32x16_bf16 v[32:47], v[212:215], v[84:87], v[32:47]
    ds_read_b128 v[108:111], v28 offset:864
    s_waitcnt lgkmcnt(5)
    v_mfma_f32_32x32x16_bf16 v[32:47], v[216:219], v[88:91], v[32:47]
    ds_read_b128 v[112:115], v28 offset:896
    s_waitcnt lgkmcnt(5)
    v_mfma_f32_32x32x16_bf16 v[32:47], v[220:223], v[92:95], v[32:47]
    ds_read_b128 v[116:119], v28 offset:928
    s_waitcnt lgkmcnt(5)
    v_mfma_f32_32x32x16_bf16 v[32:47], v[224:227], v[96:99], v[32:47]
    ds_read_b128 v[120:123], v28 offset:960
    s_waitcnt lgkmcnt(5)
    v_mfma_f32_32x32x16_bf16 v[32:47], v[228:231], v[100:103], v[32:47]
    ds_read_b128 v[124:127], v28 offset:992
    s_waitcnt lgkmcnt(5)
    v_mfma_f32_32x32x16_bf16 v[32:47], v[232:235], v[104:107], v[32:47]
    s_waitcnt lgkmcnt(4)
    v_mfma_f32_32x32x16_bf16 v[32:47], v[236:239], v[108:111], v[32:47]
    s_waitcnt lgkmcnt(3)
    v_mfma_f32_32x32x16_bf16 v[32:47], v[240:243], v[112:115], v[32:47]
    s_waitcnt lgkmcnt(2)
    v_mfma_f32_32x32x16_bf16 v[32:47], v[244:247], v[116:119], v[32:47]
    s_waitcnt lgkmcnt(1)
    v_mfma_f32_32x32x16_bf16 v[32:47], v[248:251], v[120:123], v[32:47]
    s_waitcnt lgkmcnt(0)
    v_mfma_f32_32x32x16_bf16 v[32:47], v[252:255], v[124:127], v[32:47]
L_s_qe:
    v_mov_b32 v26, 0x3eb8aa3b
    s_lshr_b32 s74, s65, 2
    s_lshl_b32 s74, s74, 15
    s_add_u32 s74, s74, 1048576
    s_lshl_b32 s72, s65, 4
    s_lshl_b32 s73, s69, 2
    s_add_u32 s72, s72, s73
    s_add_u32 s72, s72, 4096
    v_lshrrev_b32 v1, 2, v0
    s_nop 2
    v_mul_f32 v32, v32, v26
    v_mul_f32 v33, v33, v26
    v_mul_f32 v34, v34, v26
    v_mul_f32 v35, v35, v26
    v_mul_f32 v36, v36, v26
    v_mul_f32 v37, v37, v26
    v_mul_f32 v38, v38, v26
    v_mul_f32 v39, v39, v26
    v_mul_f32 v40, v40, v26
    v_mul_f32 v41, v41, v26
    v_mul_f32 v42, v42, v26
    v_mul_f32 v43, v43, v26
    v_mul_f32 v44, v44, v26
    v_mul_f32 v45, v45, v26
    v_mul_f32 v46, v46, v26
    v_mul_f32 v47, v47, v26
    v_cvt_pk_bf16_f32 v48, v32, v33
    v_cvt_pk_bf16_f32 v49, v34, v35
    v_cvt_pk_bf16_f32 v50, v36, v37
    v_cvt_pk_bf16_f32 v51, v38, v39
    v_cvt_pk_bf16_f32 v52, v40, v41
    v_cvt_pk_bf16_f32 v53, v42, v43
    v_cvt_pk_bf16_f32 v54, v44, v45
    v_cvt_pk_bf16_f32 v55, v46, v47
    v_min_u32 v48, -2, v48
    v_min_u32 v52, -2, v52
    s_mov_b32 exec_lo, 0xff
    s_mov_b32 exec_hi, 0xff
    ds_write_b128 v31, v[48:51]
    ds_write_b128 v31, v[52:55] offset:128
    s_mov_b64 exec, -1
    s_mov_b32 s98, 0
L_lw_20:
    v_mov_b32 v26, 132124
    ds_read_b32 v26, v26
    s_add_u32 s98, s98, 1
    s_cmp_gt_u32 s98, 1048576
    s_cbranch_scc1 L_end
    s_waitcnt lgkmcnt(0)
    v_readfirstlane_b32 s79, v26
    s_nop 0
    s_cmp_ge_u32 s79, 1
    s_cbranch_scc0 L_lw_20
    s_mov_b32 s28, s79
    s_cmp_eq_u32 s28, 2
    s_cbranch_scc0 L_ls_21s
    buffer_store_dwordx4 v[48:51], v30, s[60:63], s74 offen sc1
    buffer_store_dwordx4 v[52:55], v30, s[60:63], s74 offen offset:128 sc1
L_ls_21b:
    s_waitcnt vmcnt(0)
    v_mov_b32 v26, s70
    s_mov_b64 exec, 1
    s_cmp_eq_u32 s28, 2
    s_cbranch_scc0 L_ls_22s
    buffer_store_dword v26, v0, s[60:63], s72 offen
L_ls_22b:
    s_mov_b64 exec, -1
    s_mov_b32 s72, s100
    v_lshrrev_b32 v2, 8, v0
    v_and_b32 v3, 0xf0, v0
    s_cmp_lt_u32 s72, 344
    s_cbranch_scc0 L_pk_w1
    s_lshr_b32 s73, s72, 2
    s_and_b32 s74, s72, 3
    s_lshl_b32 s84, s73, 14
    s_lshl_b32 s75, s74, 8
    s_add_u32 s84, s84, s75
    s_mov_b32 s85, 4096
    s_mov_b32 s86, 4096
    s_mul_i32 s30, s74, 344
    s_add_u32 s30, s30, s73
    s_lshl_b32 s30, s30, 10
    s_add_u32 s30, s30, 17301504
    s_mov_b32 s31, 88064
    v_lshl_add_u32 v2, v2, 10, v3
    s_branch L_pk_done
L_pk_w1:
    s_sub_u32 s72, s72, 344
    s_mul_i32 s73, s72, 5958
    s_lshr_b32 s73, s73, 16
    s_mul_i32 s74, s73, 11
    s_sub_u32 s74, s72, s74
    s_lshr_b32 s75, s73, 1
    s_lshl_b32 s75, s75, 5
    s_and_b32 s76, s73, 1
    s_lshl_b32 s76, s76, 3
    s_add_u32 s75, s75, s76
    s_mul_i32 s84, s75, 2752
    s_lshl_b32 s75, s74, 8
    s_add_u32 s84, s84, s75
    s_mov_b32 s85, 11008
    s_mov_b32 s86, 33024
    s_lshl_b32 s30, s74, 7
    s_add_u32 s30, s30, s73
    s_lshl_b32 s30, s30, 10
    s_add_u32 s30, s30, 15728640
    s_mov_b32 s31, 32768
    v_mul_u32_u24 v2, 2752, v2
    v_add_u32 v2, v2, v3
L_pk_done:
    s_lshr_b32 s72, s65, 2
    s_lshl_b32 s72, s72, 6
    s_add_u32 s72, s72, 4096
    s_mov_b32 exec_lo, 0xffff
    s_mov_b32 exec_hi, 0x0
    s_mov_b32 s98, 0
    s_branch L_pf_23f
L_pf_23:
    s_sleep 1
L_pf_23f:
    buffer_load_dword v26, v1, s[60:63], s72 offen sc1
    s_add_u32 s98, s98, 1
    s_cmp_gt_u32 s98, 1048576
    s_cbranch_scc1 L_end
    s_waitcnt vmcnt(0)
    v_cmp_ne_u32 vcc, s70, v26
    s_cbranch_vccnz L_pf_23
    s_mov_b64 exec, -1
    s_cmp_eq_u32 s69, 0
    s_cbranch_scc1 L_s_nq
    s_lshl_b32 s72, s65, 13
    s_lshl_b32 s73, s69, 11
    s_add_u32 s72, s72, s73
    s_add_u32 s72, s72, 1048576
    buffer_load_dwordx4 v[48:51], v0, s[60:63], s72 offen sc1
    buffer_load_dwordx4 v[52:55], v0, s[60:63], s72 offen offset:1024 sc1
    s_add_u32 s73, s73, 133120
    v_add_u32 v1, s73, v0
    s_waitcnt vmcnt(1)
    ds_write_b128 v1, v[48:51]
    s_waitcnt vmcnt(0)
    ds_write_b128 v1, v[52:55] offset:1024
L_s_nq:
    v_lshrrev_b32 v3, 6, v0
    v_lshlrev_b32 v3, 9, v3
    v_and_b32 v28, 0x30, v0
    v_lshl_add_u32 v3, v28, 1, v3
    s_lshl_b32 s72, s69, 7
    s_add_u32 s72, s72, 229392
    s_mov_b32 s98, 0
    s_branch L_pf_24f
L_pf_24:
    s_sleep 4
L_pf_24f:
    buffer_load_dword v28, v3, s[60:63], s72 offen sc1
    s_add_u32 s98, s98, 1
    s_cmp_gt_u32 s98, 1048576
    s_cbranch_scc1 L_end
    s_waitcnt vmcnt(0)
    v_cmp_ne_u32 vcc, s70, v28
    s_cbranch_vccnz L_pf_24
    s_mov_b64 exec, -1
    s_mov_b32 s3, 0
L_s_loop0:
    s_mov_b32 s99, 0
    s_lshl_b32 s72, s1, 1
    s_add_u32 s72, s99, s72
    s_and_b32 s72, s72, 7
    s_lshl_b32 s72, s72, 16
    s_lshl_b32 s73, s69, 14
    s_add_u32 s72, s72, s73
    s_add_u32 s72, s72, 524288
    buffer_load_dwordx4 v[64:67], v0, s[60:63], s72 offen offset:0
    v_mov_b32 v32, 0
    buffer_load_dwordx4 v[68:71], v0, s[60:63], s72 offen offset:1024
    v_mov_b32 v33, 0
    buffer_load_dwordx4 v[72:75], v0, s[60:63], s72 offen offset:2048
    v_mov_b32 v34, 0
    buffer_load_dwordx4 v[76:79], v0, s[60:63], s72 offen offset:3072
    s_add_u32 s72, s72, 4096
    v_mov_b32 v35, 0
    buffer_load_dwordx4 v[80:83], v0, s[60:63], s72 offen offset:0
    v_mov_b32 v36, 0
    buffer_load_dwordx4 v[84:87], v0, s[60:63], s72 offen offset:1024
    v_mov_b32 v37, 0
    buffer_load_dwordx4 v[88:91], v0, s[60:63], s72 offen offset:2048
    v_mov_b32 v38, 0
    buffer_load_dwordx4 v[92:95], v0, s[60:63], s72 offen offset:3072
    s_add_u32 s72, s72, 4096
    v_mov_b32 v39, 0
    buffer_load_dwordx4 v[96:99], v0, s[60:63], s72 offen offset:0
    v_mov_b32 v40, 0
    buffer_load_dwordx4 v[100:103], v0, s[60:63], s72 offen offset:1024
    v_mov_b32 v41, 0
    buffer_load_dwordx4 v[104:107], v0, s[60:63], s72 offen offset:2048
    v_mov_b32 v42, 0
    buffer_load_dwordx4 v[108:111], v0, s[60:63], s72 offen offset:3072
    s_add_u32 s72, s72, 4096
    v_mov_b32 v43, 0
    buffer_load_dwordx4 v[112:115], v0, s[60:63], s72 offen offset:0
    v_mov_b32 v44, 0
    buffer_load_dwordx4 v[116:119], v0, s[60:63], s72 offen offset:1024
    v_mov_b32 v45, 0
    buffer_load_dwordx4 v[120:123], v0, s[60:63], s72 offen offset:2048
    v_mov_b32 v46, 0
    buffer_load_dwordx4 v[124:127], v0, s[60:63], s72 offen offset:3072
    v_mov_b32 v47, 0
    s_cmp_eq_u32 s101, 0
    s_cbranch_scc0 L_s_nodm2
    s_mov_b32 s98, 0
L_lw_25:
    v_mov_b32 v26, 132112
    ds_read_b32 v26, v26
    s_add_u32 s98, s98, 1
    s_cmp_gt_u32 s98, 1048576
    s_cbranch_scc1 L_end
    s_sleep 2
    s_waitcnt lgkmcnt(0)
    v_readfirstlane_b32 s79, v26
    s_nop 0
    s_cmp_ge_u32 s79, 4
    s_cbranch_scc0 L_lw_25
    s_cmp_eq_u32 s64, 5
    s_cbranch_scc0 L_s_nomr
    s_lshr_b32 s72, s65, 7
    s_mul_i32 s72, s72, 1572864
    s_and_b32 s73, s65, 127
    s_lshl_b32 s73, s73, 5
    s_add_u32 s72, s72, s73
    s_add_u32 s72, s72, 2048
    v_lshrrev_b32 v26, 5, v0
    v_mul_u32_u24 v26, 6144, v26
    v_and_b32 v27, 16, v0
    s_mov_b32 m0, 16384
    v_add_u32 v26, v26, v27
    buffer_load_dwordx4 v26, s[52:55], s72 offen lds
    s_add_u32 m0, m0, 1024
    s_add_u32 s72, s72, 196608
    buffer_load_dwordx4 v26, s[52:55], s72 offen lds
    s_add_u32 m0, m0, 1024
    s_add_u32 s72, s72, 196608
    buffer_load_dwordx4 v26, s[52:55], s72 offen lds
    s_add_u32 m0, m0, 1024
    s_add_u32 s72, s72, 196608
    buffer_load_dwordx4 v26, s[52:55], s72 offen lds
    s_add_u32 m0, m0, 1024
    s_add_u32 s72, s72, 196608
    buffer_load_dwordx4 v26, s[52:55], s72 offen lds
    s_add_u32 m0, m0, 1024
    s_add_u32 s72, s72, 196608
    buffer_load_dwordx4 v26, s[52:55], s72 offen lds
    s_add_u32 m0, m0, 1024
    s_add_u32 s72, s72, 196608
    buffer_load_dwordx4 v26, s[52:55], s72 offen lds
    s_add_u32 m0, m0, 1024
    s_add_u32 s72, s72, 196608
    buffer_load_dwordx4 v26, s[52:55], s72 offen lds
L_s_nomr:
    s_cmp_lt_u32 s100, 696
    s_cbranch_scc0 L_s_nodm2
    s_lshl_b32 m0, s69, 12
    s_add_u32 s73, s84, s85
    buffer_load_dwordx4 v2, s[44:47], s84 offen lds
    s_add_u32 m0, m0, 1024
    s_add_u32 s84, s73, s86
    buffer_load_dwordx4 v2, s[44:47], s73 offen lds
    s_add_u32 m0, m0, 1024
    s_add_u32 s73, s84, s85
    buffer_load_dwordx4 v2, s[44:47], s84 offen lds
    s_add_u32 m0, m0, 1024
    s_nop 0
    buffer_load_dwordx4 v2, s[44:47], s73 offen lds
L_s_nodm2:
    v_mov_b32 v1, 132144
    v_mov_b32 v2, -1
    v_mov_b32 v3, 0
L_s_loop:
    s_cmp_eq_u32 s99, 7
    s_cbranch_scc1 L_s_done
    s_mov_b32 s98, 0
L_s_tw:
    ds_read_b32 v48, v29
    s_add_u32 s98, s98, 1
    s_cmp_gt_u32 s98, 1048576
    s_cbranch_scc1 L_end
    s_waitcnt lgkmcnt(0)
    v_cmp_eq_u32 vcc, -1, v48
    s_cbranch_vccz L_s_tgo
    s_sleep 4
    s_branch L_s_tw
L_s_tgo:
    ds_read_b32 v56, v21 offset:0
    ds_read_b32 v57, v21 offset:128
    ds_read_b32 v58, v21 offset:256
    ds_read_b32 v59, v21 offset:384
    ds_read_b64 v[48:49], v20 offset:0
    ds_read_b64 v[50:51], v20 offset:2048
    ds_read_b64 v[52:53], v20 offset:4096
    ds_read_b64 v[54:55], v20 offset:6144
    s_waitcnt lgkmcnt(4)
    v_add_f32 v56, v56, v57
    v_add_f32 v58, v58, v59
    v_add_f32 v56, v56, v58
    v_rcp_f32 v57, v56
    s_waitcnt lgkmcnt(2)
    v_add_f32 v48, v48, v50
    v_add_f32 v49, v49, v51
    s_waitcnt lgkmcnt(0)
    v_add_f32 v52, v52, v54
    v_add_f32 v53, v53, v55
    v_add_f32 v48, v48, v52
    v_add_f32 v49, v49, v53
    v_mul_f32 v48, v48, v57
    v_mul_f32 v49, v49, v57
    v_cvt_pk_bf16_f32 v48, v48, v49
    ds_write_b32 v22, v48
    v_max3_u32 v3, v3, v56, v57
    s_mov_b64 exec, 1
    ds_sub_u32 v1, v2
    s_mov_b64 exec, -1
    s_add_u32 s99, s99, 1
    s_add_u32 s3, s3, 4
    s_mov_b32 s98, 0
L_s_mw:
    s_sleep 1
    ds_read_b32 v27, v1
    s_add_u32 s98, s98, 1
    s_cmp_gt_u32 s98, 1048576
    s_cbranch_scc1 L_end
    s_waitcnt lgkmcnt(0)
    v_readfirstlane_b32 s72, v27
    s_nop 0
    s_cmp_ge_u32 s72, s3
    s_cbranch_scc0 L_s_mw
    ds_read_b128 v[48:51], v23 offset:0
    ds_read_b128 v[52:55], v24 offset:0
    ds_read_b128 v[56:59], v23 offset:512
    ds_read_b128 v[60:63], v24 offset:512
    ds_write_b32 v29, v2
    s_waitcnt vmcnt(0) lgkmcnt(0)
    s_cmp_eq_u32 s3, 8
    s_cbranch_scc0 L_s_nodma
    v_mov_b32 v26, 132120
    v_mov_b32 v27, 1
    s_mov_b64 exec, 1
    ds_add_u32 v26, v27
    s_mov_b64 exec, -1
    s_cmp_eq_u32 s64, 5
    s_cbranch_scc0 L_s_nodma
    s_mov_b32 s98, 0
L_lw_26:
    v_mov_b32 v26, 132120
    ds_read_b32 v26, v26
    s_add_u32 s98, s98, 1
    s_cmp_gt_u32 s98, 1048576
    s_cbranch_scc1 L_end
    s_sleep 1
    s_waitcnt lgkmcnt(0)
    v_readfirstlane_b32 s79, v26
    s_nop 0
    s_cmp_ge_u32 s79, 4
    s_cbranch_scc0 L_lw_26
    s_lshr_b32 s72, s65, 7
    s_lshl_b32 s72, s72, 13
    s_and_b32 s73, s65, 127
    s_lshl_b32 s73, s73, 6
    s_add_u32 s72, s72, s73
    s_add_u32 s72, s72, 49152
    s_mov_b32 exec_lo, 0x00010001
    s_mov_b32 exec_hi, 0x00010001
    buffer_store_dwordx4 v[148:151], v152, s[60:63], s72 offen sc1
    s_mov_b64 exec, -1
L_s_nodma:
    s_cmp_eq_u32 s3, 16
    s_cbranch_scc0 L_s_nofr
    s_lshl_b32 s72, s65, 4
    s_lshl_b32 s73, s69, 2
    s_add_u32 s72, s72, s73
    s_add_u32 s72, s72, 12288
    v_mov_b32 v26, s70
    s_mov_b64 exec, 1
    s_cmp_eq_u32 s28, 2
    s_cbranch_scc0 L_ls_27s
    buffer_store_dword v26, v0, s[60:63], s72 offen
L_ls_27b:
    s_mov_b64 exec, -1
L_s_nofr:
    s_cmp_eq_u32 s3, 24
    s_cbranch_scc0 L_s_nofc
    v_bfe_u32 v26, v0, 5, 2
    v_lshlrev_b32 v26, 12, v26
    v_and_b32 v31, 16, v0
    v_lshl_add_u32 v26, v31, 3, v26
    s_lshr_b32 s72, s65, 4
    s_lshl_b32 s72, s72, 8
    s_add_u32 s72, s72, 4096
    buffer_load_dword v31, v26, s[60:63], s72 offen sc1
    s_add_u32 s72, s72, 8192
    v_lshrrev_b32 v26, 2, v0
    s_mov_b32 s98, 0
    s_branch L_pf_28f
L_pf_28:
    s_sleep 2
L_pf_28f:
    buffer_load_dword v27, v26, s[60:63], s72 offen sc1
    s_add_u32 s98, s98, 1
    s_cmp_gt_u32 s98, 1048576
    s_cbranch_scc1 L_end
    s_waitcnt vmcnt(0)
    v_cmp_ne_u32 vcc, s70, v27
    s_cbranch_vccnz L_pf_28
    s_mov_b64 exec, -1
L_s_nofc:
    s_lshl_b32 s72, s1, 1
    s_add_u32 s72, s99, s72
    s_and_b32 s72, s72, 7
    s_lshl_b32 s72, s72, 16
    s_lshl_b32 s73, s69, 14
    s_add_u32 s72, s72, s73
    s_add_u32 s72, s72, 524288
    v_mfma_f32_16x16x32_bf16 v[32:35], v[64:67], v[48:51], v[32:35]
    buffer_load_dwordx4 v[64:67], v0, s[60:63], s72 offen offset:0
    v_mfma_f32_16x16x32_bf16 v[36:39], v[68:71], v[48:51], v[36:39]
    buffer_load_dwordx4 v[68:71], v0, s[60:63], s72 offen offset:1024
    v_mfma_f32_16x16x32_bf16 v[40:43], v[72:75], v[48:51], v[40:43]
    buffer_load_dwordx4 v[72:75], v0, s[60:63], s72 offen offset:2048
    v_mfma_f32_16x16x32_bf16 v[44:47], v[76:79], v[48:51], v[44:47]
    buffer_load_dwordx4 v[76:79], v0, s[60:63], s72 offen offset:3072
    s_add_u32 s72, s72, 4096
    v_mfma_f32_16x16x32_bf16 v[32:35], v[80:83], v[52:55], v[32:35]
    buffer_load_dwordx4 v[80:83], v0, s[60:63], s72 offen offset:0
    v_mfma_f32_16x16x32_bf16 v[36:39], v[84:87], v[52:55], v[36:39]
    buffer_load_dwordx4 v[84:87], v0, s[60:63], s72 offen offset:1024
    v_mfma_f32_16x16x32_bf16 v[40:43], v[88:91], v[52:55], v[40:43]
    buffer_load_dwordx4 v[88:91], v0, s[60:63], s72 offen offset:2048
    v_mfma_f32_16x16x32_bf16 v[44:47], v[92:95], v[52:55], v[44:47]
    buffer_load_dwordx4 v[92:95], v0, s[60:63], s72 offen offset:3072
    s_add_u32 s72, s72, 4096
    v_mfma_f32_16x16x32_bf16 v[32:35], v[96:99], v[56:59], v[32:35]
    buffer_load_dwordx4 v[96:99], v0, s[60:63], s72 offen offset:0
    v_mfma_f32_16x16x32_bf16 v[36:39], v[100:103], v[56:59], v[36:39]
    buffer_load_dwordx4 v[100:103], v0, s[60:63], s72 offen offset:1024
    v_mfma_f32_16x16x32_bf16 v[40:43], v[104:107], v[56:59], v[40:43]
    buffer_load_dwordx4 v[104:107], v0, s[60:63], s72 offen offset:2048
    v_mfma_f32_16x16x32_bf16 v[44:47], v[108:111], v[56:59], v[44:47]
    buffer_load_dwordx4 v[108:111], v0, s[60:63], s72 offen offset:3072
    s_add_u32 s72, s72, 4096
    v_mfma_f32_16x16x32_bf16 v[32:35], v[112:115], v[60:63], v[32:35]
    buffer_load_dwordx4 v[112:115], v0, s[60:63], s72 offen offset:0
    v_mfma_f32_16x16x32_bf16 v[36:39], v[116:119], v[60:63], v[36:39]
    buffer_load_dwordx4 v[116:119], v0, s[60:63], s72 offen offset:1024
    v_mfma_f32_16x16x32_bf16 v[40:43], v[120:123], v[60:63], v[40:43]
    buffer_load_dwordx4 v[120:123], v0, s[60:63], s72 offen offset:2048
    v_mfma_f32_16x16x32_bf16 v[44:47], v[124:127], v[60:63], v[44:47]
    buffer_load_dwordx4 v[124:127], v0, s[60:63], s72 offen offset:3072
    s_cmp_eq_u32 s101, 0
    s_cbranch_scc0 L_s_loop
    s_cmp_lt_u32 s99, 4
    s_cbranch_scc0 L_s_pf
    s_cmp_eq_u32 s99, 2
    s_cbranch_scc1 L_s_slot1
    s_cmp_eq_u32 s99, 3
    s_cbranch_scc1 L_s_slot2
    s_cmp_eq_u32 s64, 5
    s_cbranch_scc0 L_s_nomc
    s_mov_b32 s72, 16384
    v_and_b32 v26, 0x300, v0
    v_and_b32 v27, 0xf0, v0
    v_lshrrev_b32 v27, 1, v27
    v_add3_u32 v26, v26, v27, s72
    v_lshrrev_b32 v152, 8, v0
    v_lshlrev_b32 v152, 4, v152
    v_add_u32 v27, 150272, v152
    ds_read_b64_tr_b16 v[160:161], v26 offset:0
    ds_read_b64_tr_b16 v[162:163], v26 offset:128
    ds_read_b128 v[164:167], v27 offset:0
    ds_read_b64_tr_b16 v[168:169], v26 offset:1024
    ds_read_b64_tr_b16 v[170:171], v26 offset:1152
    ds_read_b128 v[172:175], v27 offset:64
    ds_read_b64_tr_b16 v[176:177], v26 offset:2048
    ds_read_b64_tr_b16 v[178:179], v26 offset:2176
    ds_read_b128 v[180:183], v27 offset:128
    ds_read_b64_tr_b16 v[184:185], v26 offset:3072
    ds_read_b64_tr_b16 v[186:187], v26 offset:3200
    ds_read_b128 v[188:191], v27 offset:192
    ds_read_b64_tr_b16 v[192:193], v26 offset:4096
    ds_read_b64_tr_b16 v[194:195], v26 offset:4224
    ds_read_b128 v[196:199], v27 offset:256
    ds_read_b64_tr_b16 v[200:201], v26 offset:5120
    ds_read_b64_tr_b16 v[202:203], v26 offset:5248
    ds_read_b128 v[204:207], v27 offset:320
    ds_read_b64_tr_b16 v[208:209], v26 offset:6144
    ds_read_b64_tr_b16 v[210:211], v26 offset:6272
    ds_read_b128 v[212:215], v27 offset:384
    ds_read_b64_tr_b16 v[216:217], v26 offset:7168
    ds_read_b64_tr_b16 v[218:219], v26 offset:7296
    ds_read_b128 v[220:223], v27 offset:448
    s_waitcnt lgkmcnt(0)
    v_mfma_f32_16x16x32_bf16 v[148:151], v[160:163], v[164:167], 0
    s_nop 7
    v_mfma_f32_16x16x32_bf16 v[148:151], v[168:171], v[172:175], v[148:151]
    s_nop 7
    v_mfma_f32_16x16x32_bf16 v[148:151], v[176:179], v[180:183], v[148:151]
    s_nop 7
    v_mfma_f32_16x16x32_bf16 v[148:151], v[184:187], v[188:191], v[148:151]
    s_nop 7
    v_mfma_f32_16x16x32_bf16 v[148:151], v[192:195], v[196:199], v[148:151]
    s_nop 7
    v_mfma_f32_16x16x32_bf16 v[148:151], v[200:203], v[204:207], v[148:151]
    s_nop 7
    v_mfma_f32_16x16x32_bf16 v[148:151], v[208:211], v[212:215], v[148:151]
    s_nop 7
    v_mfma_f32_16x16x32_bf16 v[148:151], v[216:219], v[220:223], v[148:151]
    s_nop 7
    v_mov_b32 v26, 0xff
    s_lshr_b32 s75, s70, 0
    v_bfi_b32 v148, v26, s75, v148
    s_lshr_b32 s75, s70, 8
    v_bfi_b32 v149, v26, s75, v149
    s_lshr_b32 s75, s70, 16
    v_bfi_b32 v150, v26, s75, v150
    s_lshr_b32 s75, s70, 24
    v_bfi_b32 v151, v26, s75, v151
L_s_nomc:
    s_cmp_lt_u32 s100, 696
    s_cbranch_scc0 L_s_nopk
    s_lshl_b32 s72, s69, 12
    v_bfe_u32 v27, v0, 4, 2
    v_lshlrev_b32 v27, 3, v27
    v_bfe_u32 v28, v0, 6, 2
    v_lshrrev_b32 v26, 9, v0
    v_lshl_add_u32 v26, v26, 2, v28
    v_lshlrev_b32 v26, 8, v26
    v_bfe_u32 v28, v0, 8, 1
    v_lshl_add_u32 v26, v28, 5, v26
    v_add3_u32 v26, v26, v27, s72
    ds_read_b64_tr_b16 v[128:129], v26 offset:0
    ds_read_b64_tr_b16 v[130:131], v26 offset:2048
    ds_read_b64_tr_b16 v[132:133], v26 offset:64
    ds_read_b64_tr_b16 v[134:135], v26 offset:2112
    ds_read_b64_tr_b16 v[136:137], v26 offset:128
    ds_read_b64_tr_b16 v[138:139], v26 offset:2176
    ds_read_b64_tr_b16 v[140:141], v26 offset:192
    ds_read_b64_tr_b16 v[142:143], v26 offset:2240
    s_waitcnt lgkmcnt(6)
    buffer_store_dwordx4 v[128:131], v0, s[60:63], s30 offen sc1
    s_add_u32 s30, s30, s31
    s_waitcnt lgkmcnt(4)
    buffer_store_dwordx4 v[132:135], v0, s[60:63], s30 offen sc1
    s_add_u32 s30, s30, s31
    s_waitcnt lgkmcnt(2)
    buffer_store_dwordx4 v[136:139], v0, s[60:63], s30 offen sc1
    s_add_u32 s30, s30, s31
    s_waitcnt lgkmcnt(0)
    buffer_store_dwordx4 v[140:143], v0, s[60:63], s30 offen sc1
L_s_nopk:
    s_branch L_s_loop
L_s_slot1:
    v_subrev_u32 v26, 153600, v25
    v_lshrrev_b32 v26, 1, v26
    v_bfe_u32 v27, v0, 4, 3
    v_lshl_add_u32 v26, v27, 10, v26
    s_lshl_b32 s72, s65, 13
    buffer_load_dwordx2 v[160:161], v26, s[32:35], s72 offen offset:0
    buffer_load_dwordx2 v[162:163], v26, s[32:35], s72 offen offset:32
    buffer_load_dwordx2 v[164:165], v26, s[32:35], s72 offen offset:64
    buffer_load_dwordx2 v[166:167], v26, s[32:35], s72 offen offset:96
    s_branch L_s_loop
L_s_slot2:
    v_lshlrev_b32 v4, 16, v160
    v_and_b32 v5, 0xffff0000, v160
    v_lshlrev_b32 v6, 16, v161
    v_and_b32 v7, 0xffff0000, v161
    v_lshlrev_b32 v8, 16, v162
    v_and_b32 v9, 0xffff0000, v162
    v_lshlrev_b32 v10, 16, v163
    v_and_b32 v11, 0xffff0000, v163
    v_lshlrev_b32 v12, 16, v164
    v_and_b32 v13, 0xffff0000, v164
    v_lshlrev_b32 v14, 16, v165
    v_and_b32 v15, 0xffff0000, v165
    v_lshlrev_b32 v16, 16, v166
    v_and_b32 v17, 0xffff0000, v166
    v_lshlrev_b32 v18, 16, v167
    v_and_b32 v19, 0xffff0000, v167
    s_bfe_u32 s76, s70, 0x80000
    s_bfe_u32 s77, s70, 0x80008
    s_bfe_u32 s78, s70, 0x80010
    s_bfe_u32 s79, s70, 0x80018
    s_lshl_b32 s72, s69, 11
    s_add_u32 s72, s72, 49152
    s_add_u32 s73, s72, 8192
    s_mov_b32 s98, 0
L_poll3:
    buffer_load_dwordx4 v[128:131], v0, s[60:63], s72 offen sc1
    buffer_load_dwordx4 v[132:135], v0, s[60:63], s72 offen offset:1024 sc1
    buffer_load_dwordx4 v[136:139], v0, s[60:63], s73 offen sc1
    buffer_load_dwordx4 v[140:143], v0, s[60:63], s73 offen offset:1024 sc1
    s_add_u32 s98, s98, 1
    s_cmp_gt_u32 s98, 1048576
    s_cbranch_scc1 L_end
    s_waitcnt vmcnt(0)
    v_xor_b32 v128, s76, v128
    v_xor_b32 v129, s77, v129
    v_xor_b32 v130, s78, v130
    v_xor_b32 v131, s79, v131
    v_or3_b32 v26, v128, v129, v130
    v_or_b32 v26, v26, v131
    v_xor_b32 v132, s76, v132
    v_xor_b32 v133, s77, v133
    v_xor_b32 v134, s78, v134
    v_xor_b32 v135, s79, v135
    v_or3_b32 v26, v26, v132, v133
    v_or3_b32 v26, v26, v134, v135
    v_xor_b32 v136, s76, v136
    v_xor_b32 v137, s77, v137
    v_xor_b32 v138, s78, v138
    v_xor_b32 v139, s79, v139
    v_or3_b32 v26, v26, v136, v137
    v_or3_b32 v26, v26, v138, v139
    v_xor_b32 v140, s76, v140
    v_xor_b32 v141, s77, v141
    v_xor_b32 v142, s78, v142
    v_xor_b32 v143, s79, v143
    v_or3_b32 v26, v26, v140, v141
    v_or3_b32 v26, v26, v142, v143
    v_and_b32 v26, 0xff, v26
    v_cmp_ne_u32 vcc, 0, v26
    s_cbranch_vccnz L_poll3
    v_add_f32 v128, v128, v136
    v_add_f32 v129, v129, v137
    v_add_f32 v130, v130, v138
    v_add_f32 v131, v131, v139
    v_add_f32 v132, v132, v140
    v_add_f32 v133, v133, v141
    v_add_f32 v134, v134, v142
    v_add_f32 v135, v135, v143
    v_cvt_pk_bf16_f32 v136, v128, v129
    v_cvt_pk_bf16_f32 v137, v130, v131
    v_cvt_pk_bf16_f32 v138, v132, v133
    v_cvt_pk_bf16_f32 v139, v134, v135
    v_lshlrev_b32 v128, 16, v136
    v_and_b32 v129, 0xffff0000, v136
    v_lshlrev_b32 v130, 16, v137
    v_and_b32 v131, 0xffff0000, v137
    v_lshlrev_b32 v132, 16, v138
    v_and_b32 v133, 0xffff0000, v138
    v_lshlrev_b32 v134, 16, v139
    v_and_b32 v135, 0xffff0000, v139
    s_cmp_eq_u32 s69, 2
    s_cbranch_scc0 L_s_noadd
    v_add_f32 v128, 1.0, v128
    v_add_f32 v129, 1.0, v129
    v_add_f32 v130, 1.0, v130
    v_add_f32 v131, 1.0, v131
    v_add_f32 v132, 1.0, v132
    v_add_f32 v133, 1.0, v133
    v_add_f32 v134, 1.0, v134
    v_add_f32 v135, 1.0, v135
    v_cvt_pk_bf16_f32 v136, v128, v129
    v_cvt_pk_bf16_f32 v137, v130, v131
    v_cvt_pk_bf16_f32 v138, v132, v133
    v_cvt_pk_bf16_f32 v139, v134, v135
    v_lshlrev_b32 v128, 16, v136
    v_and_b32 v129, 0xffff0000, v136
    v_lshlrev_b32 v130, 16, v137
    v_and_b32 v131, 0xffff0000, v137
    v_lshlrev_b32 v132, 16, v138
    v_and_b32 v133, 0xffff0000, v138
    v_lshlrev_b32 v134, 16, v139
    v_and_b32 v135, 0xffff0000, v139
L_s_noadd:
    s_cmp_eq_u32 s69, 0
    s_cselect_b32 s72, 1.0, 0xbfb8aa3b
    s_cmp_eq_u32 s69, 3
    s_cselect_b32 s72, 0xbf317218, s72
    v_mul_f32 v128, s72, v128
    v_mul_f32 v129, s72, v129
    v_mul_f32 v130, s72, v130
    v_mul_f32 v131, s72, v131
    v_mul_f32 v132, s72, v132
    v_mul_f32 v133, s72, v133
    v_mul_f32 v134, s72, v134
    v_mul_f32 v135, s72, v135
    s_lshl_b32 s72, s69, 11
    s_add_u32 s72, s72, 153600
    v_add_u32 v26, s72, v0
    ds_write_b128 v26, v[128:131]
    ds_write_b128 v26, v[132:135] offset:1024
    s_mul_i32 s72, s66, 176128
    s_lshl_b32 s73, s69, 13
    s_add_u32 s72, s72, s73
    s_add_u32 s30, s72, 17301504
    s_add_u32 s31, s30, 88064
    v_mov_b32 v48, -1
    v_mov_b32 v49, -1
    v_mov_b32 v50, -1
    v_mov_b32 v51, -1
    s_lshl_b32 s72, s65, 2
    s_add_u32 s72, s72, s69
    s_mul_i32 s73, s72, 5504
    s_add_u32 s73, s73, 9437184
    s_add_u32 s74, s73, 4096
    s_lshl_b32 s72, s72, 11
    s_add_u32 s72, s72, 3145728
    buffer_store_dwordx4 v[48:51], v0, s[60:63], s72 offen offset:0 sc1
    buffer_store_dwordx4 v[48:51], v0, s[60:63], s72 offen offset:1024 sc1
    buffer_store_dwordx4 v[48:51], v0, s[60:63], s73 offen offset:0 sc1
    buffer_store_dwordx4 v[48:51], v0, s[60:63], s73 offen offset:1024 sc1
    buffer_store_dwordx4 v[48:51], v0, s[60:63], s73 offen offset:2048 sc1
    buffer_store_dwordx4 v[48:51], v0, s[60:63], s73 offen offset:3072 sc1
    buffer_store_dwordx4 v[48:51], v0, s[60:63], s74 offen offset:0 sc1
    s_mov_b64 exec, 0xffffff
    buffer_store_dwordx4 v[48:51], v0, s[60:63], s74 offen offset:1024 sc1
    s_mov_b64 exec, -1
    s_sub_u32 s72, s72, 3145728
    buffer_store_dwordx4 v[48:51], v0, s[56:59], s72 offen offset:0 sc1
    buffer_store_dwordx4 v[48:51], v0, s[56:59], s72 offen offset:1024 sc1
    s_branch L_s_loop
L_s_pf:
    s_cmp_eq_u32 s99, 4
    s_cbranch_scc0 L_s_pf4
    s_lshl_b32 s75, s69, 13
    s_lshl_b32 s73, s68, 15
    s_add_u32 s73, s73, s75
    s_add_u32 s73, s73, 15728640
    s_add_u32 m0, s75, 0
    s_add_u32 s74, s73, 4096
    buffer_load_dwordx4 v0, s[60:63], s73 offen offset:0 lds
    buffer_load_dwordx4 v0, s[60:63], s73 offen offset:1024 lds
    buffer_load_dwordx4 v0, s[60:63], s73 offen offset:2048 lds
    buffer_load_dwordx4 v0, s[60:63], s73 offen offset:3072 lds
    s_add_u32 m0, m0, 4096
    s_nop 0
    buffer_load_dwordx4 v0, s[60:63], s74 offen offset:0 lds
    buffer_load_dwordx4 v0, s[60:63], s74 offen offset:1024 lds
    buffer_load_dwordx4 v0, s[60:63], s74 offen offset:2048 lds
    buffer_load_dwordx4 v0, s[60:63], s74 offen offset:3072 lds
L_jw_29:
    s_add_u32 s72, s30, 0
    s_add_u32 s73, s31, 0
    buffer_load_dwordx4 v[192:195], v0, s[60:63], s72 offen offset:0
    buffer_load_dwordx4 v[196:199], v0, s[60:63], s73 offen offset:0
    buffer_load_dwordx4 v[200:203], v0, s[60:63], s72 offen offset:1024
    buffer_load_dwordx4 v[204:207], v0, s[60:63], s73 offen offset:1024
    buffer_load_dwordx4 v[208:211], v0, s[60:63], s72 offen offset:2048
    buffer_load_dwordx4 v[212:215], v0, s[60:63], s73 offen offset:2048
    buffer_load_dwordx4 v[216:219], v0, s[60:63], s72 offen offset:3072
    buffer_load_dwordx4 v[220:223], v0, s[60:63], s73 offen offset:3072
    s_lshl_b32 s75, s69, 13
    s_lshl_b32 s73, s68, 15
    s_add_u32 s73, s73, s75
    s_add_u32 s73, s73, 16777216
    s_add_u32 m0, s75, 65536
    s_add_u32 s74, s73, 4096
    s_cmp_lt_u32 s68, 11
    s_cbranch_scc0 L_jw_30
    buffer_load_dwordx4 v0, s[60:63], s73 offen offset:0 lds
    buffer_load_dwordx4 v0, s[60:63], s73 offen offset:1024 lds
    buffer_load_dwordx4 v0, s[60:63], s73 offen offset:2048 lds
    buffer_load_dwordx4 v0, s[60:63], s73 offen offset:3072 lds
    s_add_u32 m0, m0, 4096
    s_nop 0
    buffer_load_dwordx4 v0, s[60:63], s74 offen offset:0 lds
    buffer_load_dwordx4 v0, s[60:63], s74 offen offset:1024 lds
    buffer_load_dwordx4 v0, s[60:63], s74 offen offset:2048 lds
    buffer_load_dwordx4 v0, s[60:63], s74 offen offset:3072 lds
L_jw_30:
    s_branch L_s_loop
L_s_pf4:
    s_cmp_eq_u32 s99, 5
    s_cbranch_scc0 L_s_pf5
    s_lshl_b32 s75, s69, 13
    s_lshl_b32 s73, s68, 15
    s_add_u32 s73, s73, s75
    s_add_u32 s73, s73, 16252928
    s_add_u32 m0, s75, 32768
    s_add_u32 s74, s73, 4096
    buffer_load_dwordx4 v0, s[60:63], s73 offen offset:0 lds
    buffer_load_dwordx4 v0, s[60:63], s73 offen offset:1024 lds
    buffer_load_dwordx4 v0, s[60:63], s73 offen offset:2048 lds
    buffer_load_dwordx4 v0, s[60:63], s73 offen offset:3072 lds
    s_add_u32 m0, m0, 4096
    s_nop 0
    buffer_load_dwordx4 v0, s[60:63], s74 offen offset:0 lds
    buffer_load_dwordx4 v0, s[60:63], s74 offen offset:1024 lds
    buffer_load_dwordx4 v0, s[60:63], s74 offen offset:2048 lds
    buffer_load_dwordx4 v0, s[60:63], s74 offen offset:3072 lds
L_jw_31:
    v_lshlrev_b32 v26, 3, v0
    s_mul_i32 s72, s65, 22016
    s_lshl_b32 s73, s69, 13
    s_add_u32 s72, s72, s73
    s_add_u32 s72, s72, 9437184
    s_lshl_b32 s73, s65, 13
    s_add_u32 s73, s73, 3145728
    s_cmp_eq_u32 s69, 3
    s_cselect_b32 s72, s73, s72
    buffer_load_dword v30, v26, s[60:63], s72 offen sc1
L_tc_32:
    v_lshlrev_b32 v26, 3, v0
    s_cmp_eq_u32 s69, 0
    s_cbranch_scc0 L_tc_33
    s_lshl_b32 s72, s65, 13
    buffer_load_dword v31, v26, s[56:59], s72 offen sc1
L_tc_33:
    s_branch L_s_loop
L_s_pf5:
    s_cmp_eq_u32 s99, 6
    s_cbranch_scc0 L_s_pf6
    s_add_u32 s72, s30, 4096
    s_add_u32 s73, s31, 4096
    buffer_load_dwordx4 v[224:227], v0, s[60:63], s72 offen offset:0
    buffer_load_dwordx4 v[228:231], v0, s[60:63], s73 offen offset:0
    buffer_load_dwordx4 v[232:235], v0, s[60:63], s72 offen offset:1024
    buffer_load_dwordx4 v[236:239], v0, s[60:63], s73 offen offset:1024
    buffer_load_dwordx4 v[240:243], v0, s[60:63], s72 offen offset:2048
    buffer_load_dwordx4 v[244:247], v0, s[60:63], s73 offen offset:2048
    buffer_load_dwordx4 v[248:251], v0, s[60:63], s72 offen offset:3072
    buffer_load_dwordx4 v[252:255], v0, s[60:63], s73 offen offset:3072
    s_add_u32 s72, s30, 32768
    s_add_u32 s73, s31, 32768
    buffer_load_dwordx4 v[128:131], v0, s[60:63], s72 offen offset:0
    buffer_load_dwordx4 v[132:135], v0, s[60:63], s73 offen offset:0
    buffer_load_dwordx4 v[136:139], v0, s[60:63], s72 offen offset:1024
    buffer_load_dwordx4 v[140:143], v0, s[60:63], s73 offen offset:1024
    buffer_load_dwordx4 v[144:147], v0, s[60:63], s72 offen offset:2048
    buffer_load_dwordx4 v[148:151], v0, s[60:63], s73 offen offset:2048
    buffer_load_dwordx4 v[152:155], v0, s[60:63], s72 offen offset:3072
    buffer_load_dwordx4 v[156:159], v0, s[60:63], s73 offen offset:3072
    s_branch L_s_loop
L_s_pf6:
    s_add_u32 s72, s30, 36864
    s_add_u32 s73, s31, 36864
    buffer_load_dwordx4 v[160:163], v0, s[60:63], s72 offen offset:0
    buffer_load_dwordx4 v[164:167], v0, s[60:63], s73 offen offset:0
    buffer_load_dwordx4 v[168:171], v0, s[60:63], s72 offen offset:1024
    buffer_load_dwordx4 v[172:175], v0, s[60:63], s73 offen offset:1024
    buffer_load_dwordx4 v[176:179], v0, s[60:63], s72 offen offset:2048
    buffer_load_dwordx4 v[180:183], v0, s[60:63], s73 offen offset:2048
    buffer_load_dwordx4 v[184:187], v0, s[60:63], s72 offen offset:3072
    buffer_load_dwordx4 v[188:191], v0, s[60:63], s73 offen offset:3072
    s_branch L_s_loop
L_s_done:
    v_bfe_u32 v27, v0, 4, 3
    v_lshrrev_b32 v28, 9, v0
    v_lshlrev_b32 v28, 7, v28
    v_lshl_add_u32 v28, v27, 4, v28
    s_lshl_b32 s73, s69, 2
    s_add_u32 s73, s73, 132160
    v_add_u32 v28, s73, v28
    s_mov_b32 s72, 0x53800000
    s_barrier
    ds_read_b32 v56, v21 offset:0
    ds_read_b32 v57, v21 offset:128
    ds_read_b32 v58, v21 offset:256
    ds_read_b32 v59, v21 offset:384
    ds_read_b64 v[48:49], v20 offset:0
    ds_read_b64 v[50:51], v20 offset:2048
    ds_read_b64 v[52:53], v20 offset:4096
    ds_read_b64 v[54:55], v20 offset:6144
    s_waitcnt lgkmcnt(4)
    v_add_f32 v56, v56, v57
    v_add_f32 v58, v58, v59
    v_add_f32 v56, v56, v58
    v_rcp_f32 v57, v56
    s_waitcnt lgkmcnt(2)
    v_add_f32 v48, v48, v50
    v_add_f32 v49, v49, v51
    s_waitcnt lgkmcnt(0)
    v_add_f32 v52, v52, v54
    v_add_f32 v53, v53, v55
    v_add_f32 v48, v48, v52
    v_add_f32 v49, v49, v53
    v_mul_f32 v48, v48, v57
    v_mul_f32 v49, v49, v57
    v_cvt_pk_bf16_f32 v48, v48, v49
    ds_write_b32 v22, v48
    v_max3_u32 v3, v3, v56, v57
    v_cmp_lt_u32 vcc, s72, v3
    s_cbranch_vccz L_s_ok
    v_mov_b32 v26, 132128
    v_mov_b32 v30, 1
    ds_write_b32 v26, v30
L_s_ok:
    s_waitcnt lgkmcnt(0)
    s_barrier
    ds_read_b128 v[48:51], v23 offset:0
    ds_read_b128 v[52:55], v24 offset:0
    ds_read_b128 v[56:59], v23 offset:512
    ds_read_b128 v[60:63], v24 offset:512
    ds_write_b32 v29, v2
    s_cmp_eq_u32 s101, 0
    s_cbranch_scc1 L_s_wy
    s_waitcnt vmcnt(0)
L_s_wy:
    s_waitcnt vmcnt(8) lgkmcnt(0)
    v_mfma_f32_16x16x32_bf16 v[32:35], v[64:67], v[48:51], v[32:35]
    ds_read_b128 v[64:67], v25 offset:0
    v_mfma_f32_16x16x32_bf16 v[36:39], v[68:71], v[48:51], v[36:39]
    ds_read_b128 v[68:71], v25 offset:64
    v_mfma_f32_16x16x32_bf16 v[40:43], v[72:75], v[48:51], v[40:43]
    ds_read_b128 v[72:75], v25 offset:128
    v_mfma_f32_16x16x32_bf16 v[44:47], v[76:79], v[48:51], v[44:47]
    ds_read_b128 v[76:79], v25 offset:192
    v_mfma_f32_16x16x32_bf16 v[32:35], v[80:83], v[52:55], v[32:35]
    ds_read_b128 v[80:83], v25 offset:4096
    v_mfma_f32_16x16x32_bf16 v[36:39], v[84:87], v[52:55], v[36:39]
    ds_read_b128 v[84:87], v25 offset:4160
    v_mfma_f32_16x16x32_bf16 v[40:43], v[88:91], v[52:55], v[40:43]
    ds_read_b128 v[88:91], v25 offset:4224
    v_mfma_f32_16x16x32_bf16 v[44:47], v[92:95], v[52:55], v[44:47]
    ds_read_b128 v[92:95], v25 offset:4288
    v_mfma_f32_16x16x32_bf16 v[32:35], v[96:99], v[56:59], v[32:35]
    ds_read_b128 v[96:99], v25 offset:2048
    v_mfma_f32_16x16x32_bf16 v[36:39], v[100:103], v[56:59], v[36:39]
    ds_read_b128 v[100:103], v25 offset:2112
    v_mfma_f32_16x16x32_bf16 v[40:43], v[104:107], v[56:59], v[40:43]
    ds_read_b128 v[104:107], v25 offset:2176
    v_mfma_f32_16x16x32_bf16 v[44:47], v[108:111], v[56:59], v[44:47]
    ds_read_b128 v[108:111], v25 offset:2240
    v_mfma_f32_16x16x32_bf16 v[32:35], v[112:115], v[60:63], v[32:35]
    v_mfma_f32_16x16x32_bf16 v[36:39], v[116:119], v[60:63], v[36:39]
    v_mfma_f32_16x16x32_bf16 v[40:43], v[120:123], v[60:63], v[40:43]
    v_mfma_f32_16x16x32_bf16 v[44:47], v[124:127], v[60:63], v[44:47]
    s_lshl_b32 s72, s65, 13
    v_lshlrev_b32 v27, 4, v27
    v_add_u32 v26, 132160, v27
    s_waitcnt lgkmcnt(8)
    s_nop 0
    v_pk_fma_f32 v[32:33], v[32:33], v[64:65], v[4:5]
    v_pk_fma_f32 v[34:35], v[34:35], v[66:67], v[6:7]
    v_pk_fma_f32 v[36:37], v[36:37], v[68:69], v[8:9]
    v_pk_fma_f32 v[38:39], v[38:39], v[70:71], v[10:11]
    v_pk_fma_f32 v[40:41], v[40:41], v[72:73], v[12:13]
    v_pk_fma_f32 v[42:43], v[42:43], v[74:75], v[14:15]
    v_pk_fma_f32 v[44:45], v[44:45], v[76:77], v[16:17]
    v_pk_fma_f32 v[46:47], v[46:47], v[78:79], v[18:19]
    v_pk_add_f32 v[48:49], v[32:33], v[34:35]
    v_pk_mul_f32 v[50:51], v[32:33], v[32:33]
    v_pk_fma_f32 v[50:51], v[34:35], v[34:35], v[50:51]
    v_pk_add_f32 v[48:49], v[48:49], v[36:37]
    v_pk_fma_f32 v[50:51], v[36:37], v[36:37], v[50:51]
    v_pk_add_f32 v[48:49], v[48:49], v[38:39]
    v_pk_fma_f32 v[50:51], v[38:39], v[38:39], v[50:51]
    v_pk_add_f32 v[48:49], v[48:49], v[40:41]
    v_pk_fma_f32 v[50:51], v[40:41], v[40:41], v[50:51]
    v_pk_add_f32 v[48:49], v[48:49], v[42:43]
    v_pk_fma_f32 v[50:51], v[42:43], v[42:43], v[50:51]
    v_pk_add_f32 v[48:49], v[48:49], v[44:45]
    v_pk_fma_f32 v[50:51], v[44:45], v[44:45], v[50:51]
    v_pk_add_f32 v[48:49], v[48:49], v[46:47]
    v_pk_fma_f32 v[50:51], v[46:47], v[46:47], v[50:51]
    v_add_f32 v48, v48, v49
    v_add_f32 v50, v50, v51
    v_bfe_u32 v2, v0, 7, 1
    v_lshl_add_u32 v27, v2, 12, v27
    v_permlane32_swap_b32 v48, v50
    v_add_f32 v48, v48, v50
    v_lshrrev_b32 v2, 8, v0
    v_lshl_add_u32 v27, v2, 9, v27
    v_add_f32_dpp v48, v48, v48 row_ror:8 row_mask:0xf bank_mask:0xf
    v_mov_b32 v49, v48
    v_mov_b32 v30, 0x3b000000
    v_mov_b32 v31, 0x3727c5ac
    v_permlane16_swap_b32 v48, v49
    v_add_f32 v48, v48, v49
    ds_write_b32 v28, v48
    s_lshr_b32 s74, s65, 2
    s_lshl_b32 s74, s74, 15
    s_and_b32 s73, s65, 3
    s_lshl_b32 s73, s73, 7
    s_add_u32 s74, s74, s73
    s_lshl_b32 s73, s69, 13
    s_add_u32 s74, s74, s73
    s_add_u32 s74, s74, 3145728
    s_waitcnt lgkmcnt(0)
    s_barrier
    v_mov_b32 v28, 132128
    ds_read_b32 v28, v28
    ds_read_b128 v[48:51], v26
    ds_read_b128 v[52:55], v26 offset:128
    s_waitcnt lgkmcnt(1)
    v_readfirstlane_b32 s73, v28
    v_pk_add_f32 v[48:49], v[48:49], v[50:51]
    s_cmp_lg_u32 s73, s101
    s_cbranch_scc1 L_s_safe
    s_waitcnt lgkmcnt(0)
    v_pk_add_f32 v[52:53], v[52:53], v[54:55]
    v_add_f32 v48, v48, v49
    v_add_f32 v52, v52, v53
    v_mul_f32 v48, v30, v48
    v_fma_f32 v52, v52, v30, v31
    v_fma_f32 v52, -v48, v48, v52
    v_max_f32 v52, v31, v52
    v_rsq_f32 v50, v52
    s_nop 0
    v_mul_f32_e64 v51, v48, -v50
    v_pk_fma_f32 v[4:5], v[32:33], v[50:51], v[50:51] op_sel:[0,0,1] op_sel_hi:[1,0,1]
    v_pk_fma_f32 v[6:7], v[34:35], v[50:51], v[50:51] op_sel:[0,0,1] op_sel_hi:[1,0,1]
    v_pk_fma_f32 v[8:9], v[36:37], v[50:51], v[50:51] op_sel:[0,0,1] op_sel_hi:[1,0,1]
    v_pk_fma_f32 v[10:11], v[38:39], v[50:51], v[50:51] op_sel:[0,0,1] op_sel_hi:[1,0,1]
    v_pk_fma_f32 v[12:13], v[40:41], v[50:51], v[50:51] op_sel:[0,0,1] op_sel_hi:[1,0,1]
    v_pk_fma_f32 v[14:15], v[42:43], v[50:51], v[50:51] op_sel:[0,0,1] op_sel_hi:[1,0,1]
    v_pk_fma_f32 v[16:17], v[44:45], v[50:51], v[50:51] op_sel:[0,0,1] op_sel_hi:[1,0,1]
    v_pk_fma_f32 v[18:19], v[46:47], v[50:51], v[50:51] op_sel:[0,0,1] op_sel_hi:[1,0,1]
    v_pk_fma_f32 v[4:5], v[4:5], v[80:81], v[96:97]
    v_pk_fma_f32 v[6:7], v[6:7], v[82:83], v[98:99]
    v_pk_fma_f32 v[8:9], v[8:9], v[84:85], v[100:101]
    v_pk_fma_f32 v[10:11], v[10:11], v[86:87], v[102:103]
    v_pk_fma_f32 v[12:13], v[12:13], v[88:89], v[104:105]
    v_pk_fma_f32 v[14:15], v[14:15], v[90:91], v[106:107]
    v_pk_fma_f32 v[16:17], v[16:17], v[92:93], v[108:109]
    v_pk_fma_f32 v[18:19], v[18:19], v[94:95], v[110:111]
    v_cvt_pk_bf16_f32 v56, v4, v5
    v_cvt_pk_bf16_f32 v57, v6, v7
    v_cvt_pk_bf16_f32 v58, v8, v9
    v_cvt_pk_bf16_f32 v59, v10, v11
    v_cvt_pk_bf16_f32 v60, v12, v13
    v_cvt_pk_bf16_f32 v61, v14, v15
    v_cvt_pk_bf16_f32 v62, v16, v17
    v_cvt_pk_bf16_f32 v63, v18, v19
    v_min_u32 v56, -2, v56
    v_min_u32 v60, -2, v60
    s_cmp_eq_u32 s28, 2
    s_cbranch_scc0 L_ls_34s
    buffer_store_dwordx4 v[56:59], v27, s[60:63], s74 offen nt
    buffer_store_dwordx4 v[60:63], v27, s[60:63], s74 offen offset:2048 nt
L_ls_34b:
    s_waitcnt vmcnt(2)
    v_mov_b32 v26, 132496
    v_mov_b32 v27, 1
    s_mov_b64 exec, 1
    ds_add_u32 v26, v27
    s_mov_b64 exec, -1
    s_setprio 0
    s_mov_b32 s98, 0
L_lw_35:
    v_mov_b32 v26, 132504
    ds_read_b32 v26, v26
    s_add_u32 s98, s98, 1
    s_cmp_gt_u32 s98, 1048576
    s_cbranch_scc1 L_end
    s_sleep 2
    s_waitcnt lgkmcnt(0)
    v_readfirstlane_b32 s79, v26
    s_nop 0
    s_cmp_ge_u32 s79, 4
    s_cbranch_scc0 L_lw_35
    v_cvt_pk_bf16_f32 v64, v32, v33
    v_cvt_pk_bf16_f32 v65, v34, v35
    v_cvt_pk_bf16_f32 v66, v36, v37
    v_cvt_pk_bf16_f32 v67, v38, v39
    v_cvt_pk_bf16_f32 v68, v40, v41
    v_cvt_pk_bf16_f32 v69, v42, v43
    v_cvt_pk_bf16_f32 v70, v44, v45
    v_cvt_pk_bf16_f32 v71, v46, v47
    v_bfe_u32 v3, v0, 4, 3
    v_lshlrev_b32 v3, 10, v3
    v_bfe_u32 v2, v0, 7, 1
    v_lshl_add_u32 v3, v2, 7, v3
    v_bfe_u32 v2, v0, 8, 1
    v_lshl_add_u32 v3, v2, 5, v3
    v_lshrrev_b32 v2, 9, v0
    v_lshl_add_u32 v3, v2, 4, v3
    s_lshl_b32 s73, s69, 8
    s_add_u32 s72, s72, s73
    v_permlane16_swap_b32 v64, v66
    v_permlane16_swap_b32 v65, v67
    v_permlane16_swap_b32 v68, v70
    v_permlane16_swap_b32 v69, v71
    s_cmp_eq_u32 s28, 2
    s_cbranch_scc0 L_ls_36s
    buffer_store_dwordx4 v[64:67], v3, s[56:59], s72 offen offset:0
    buffer_store_dwordx4 v[68:71], v3, s[56:59], s72 offen offset:64
L_ls_36b:
    s_lshl_b32 s72, s65, 4
    s_lshl_b32 s73, s69, 2
    s_add_u32 s72, s72, s73
    s_add_u32 s72, s72, 8192
    s_waitcnt vmcnt(0)
    v_mov_b32 v26, s70
    s_mov_b64 exec, 1
    s_cmp_eq_u32 s28, 2
    s_cbranch_scc0 L_ls_37s
    buffer_store_dword v26, v0, s[60:63], s72 offen
L_ls_37b:
    s_mov_b64 exec, -1
    s_setprio 0
    s_mul_i32 s80, s67, 176128
    s_lshl_b32 s72, s69, 13
    s_add_u32 s80, s80, s72
    s_add_u32 s80, s80, 9437184
    s_add_u32 s81, s80, 88064
    s_lshl_b32 s83, s69, 11
    s_sub_u32 s83, 65536, s83
    s_add_u32 s82, s83, 4096
    s_cmp_eq_u32 s69, 3
    s_cselect_b32 s82, 0x40000000, s82
    s_add_u32 s72, s72, 98304
    v_add_u32 v2, s72, v0
    s_add_u32 s72, s30, s82
    buffer_load_dwordx4 v[68:71], v0, s[60:63], s72 offen offset:0
    s_add_u32 s72, s31, s82
    buffer_load_dwordx4 v[72:75], v0, s[60:63], s72 offen offset:0
    s_add_u32 s72, s30, s82
    buffer_load_dwordx4 v[76:79], v0, s[60:63], s72 offen offset:1024
    s_add_u32 s72, s31, s82
    buffer_load_dwordx4 v[80:83], v0, s[60:63], s72 offen offset:1024
    s_and_b32 s73, s67, 1
    s_lshl_b32 s73, s73, 3
    s_add_u32 s73, s73, 132480
    s_add_u32 s74, s73, 4
    s_mov_b32 s98, 0
L_lw_38:
    v_mov_b32 v3, s73
    ds_read_b32 v3, v3
    s_add_u32 s98, s98, 1
    s_cmp_gt_u32 s98, 1048576
    s_cbranch_scc1 L_end
    s_sleep 1
    s_waitcnt lgkmcnt(0)
    v_readfirstlane_b32 s79, v3
    s_nop 0
    s_cmp_ge_u32 s79, 1
    s_cbranch_scc0 L_lw_38
    s_mov_b32 s98, 0
L_lw_39:
    v_mov_b32 v3, s74
    ds_read_b32 v3, v3
    s_add_u32 s98, s98, 1
    s_cmp_gt_u32 s98, 1048576
    s_cbranch_scc1 L_end
    s_sleep 1
    s_waitcnt lgkmcnt(0)
    v_readfirstlane_b32 s79, v3
    s_nop 0
    s_cmp_ge_u32 s79, 1
    s_cbranch_scc0 L_lw_39
    s_setprio 0
    s_add_u32 s72, s80, 0
    buffer_load_dwordx4 v[84:87], v0, s[60:63], s72 offen offset:0 sc1
    s_add_u32 s72, s81, 0
    buffer_load_dwordx4 v[88:91], v0, s[60:63], s72 offen offset:0 sc1
    s_add_u32 s72, s80, 0
    buffer_load_dwordx4 v[92:95], v0, s[60:63], s72 offen offset:1024 sc1
    s_add_u32 s72, s81, 0
    buffer_load_dwordx4 v[96:99], v0, s[60:63], s72 offen offset:1024 sc1
    s_add_u32 s72, s80, 0
    buffer_load_dwordx4 v[100:103], v0, s[60:63], s72 offen offset:2048 sc1
    s_add_u32 s72, s81, 0
    buffer_load_dwordx4 v[104:107], v0, s[60:63], s72 offen offset:2048 sc1
    s_add_u32 s72, s80, 0
    buffer_load_dwordx4 v[108:111], v0, s[60:63], s72 offen offset:3072 sc1
    s_add_u32 s72, s81, 0
    buffer_load_dwordx4 v[112:115], v0, s[60:63], s72 offen offset:3072 sc1
    s_waitcnt vmcnt(6)
    v_max_u32 v3, v84, v88
    v_cmp_eq_u32 vcc, -1, v3
    s_cbranch_vccnz L_bc_40r
L_bc_40:
    v_mfma_f32_32x32x16_bf16 v[4:19], v[192:195], v[84:87], 0
    s_add_u32 s72, s80, 4096
    buffer_load_dwordx4 v[116:119], v0, s[60:63], s72 offen offset:0 sc1
    s_add_u32 s72, s81, 4096
    buffer_load_dwordx4 v[120:123], v0, s[60:63], s72 offen offset:0 sc1
    v_mfma_f32_32x32x16_bf16 v[20:35], v[196:199], v[84:87], 0
    s_waitcnt vmcnt(6)
    v_max_u32 v3, v92, v96
    v_cmp_eq_u32 vcc, -1, v3
    v_mfma_f32_32x32x16_bf16 v[36:51], v[192:195], v[88:91], 0
    s_add_u32 s72, s80, 4096
    buffer_load_dwordx4 v[124:127], v0, s[60:63], s72 offen offset:1024 sc1
    v_mfma_f32_32x32x16_bf16 v[52:67], v[196:199], v[88:91], 0
    s_cbranch_vccnz L_bc_41r
L_bc_41:
    v_mfma_f32_32x32x16_bf16 v[4:19], v[200:203], v[92:95], v[4:19]
    s_add_u32 s72, s81, 4096
    buffer_load_dwordx4 v[192:195], v0, s[60:63], s72 offen offset:1024 sc1
    s_add_u32 s72, s80, 4096
    buffer_load_dwordx4 v[84:87], v0, s[60:63], s72 offen offset:2048 sc1
    v_mfma_f32_32x32x16_bf16 v[20:35], v[204:207], v[92:95], v[20:35]
    s_waitcnt vmcnt(7)
    v_max_u32 v3, v100, v104
    v_cmp_eq_u32 vcc, -1, v3
    v_mfma_f32_32x32x16_bf16 v[36:51], v[200:203], v[96:99], v[36:51]
    s_add_u32 s72, s81, 4096
    buffer_load_dwordx4 v[196:199], v0, s[60:63], s72 offen offset:2048 sc1
    s_add_u32 s72, s80, 4096
    buffer_load_dwordx4 v[88:91], v0, s[60:63], s72 offen offset:3072 sc1
    v_mfma_f32_32x32x16_bf16 v[52:67], v[204:207], v[96:99], v[52:67]
    s_cbranch_vccnz L_bc_42r
L_bc_42:
    v_mfma_f32_32x32x16_bf16 v[4:19], v[208:211], v[100:103], v[4:19]
    s_add_u32 s72, s81, 4096
    buffer_load_dwordx4 v[200:203], v0, s[60:63], s72 offen offset:3072 sc1
    v_mfma_f32_32x32x16_bf16 v[20:35], v[212:215], v[100:103], v[20:35]
    s_waitcnt vmcnt(8)
    v_max_u32 v3, v108, v112
    v_cmp_eq_u32 vcc, -1, v3
    v_mfma_f32_32x32x16_bf16 v[36:51], v[208:211], v[104:107], v[36:51]
    v_mfma_f32_32x32x16_bf16 v[52:67], v[212:215], v[104:107], v[52:67]
    s_cbranch_vccnz L_bc_43r
L_bc_43:
    v_mfma_f32_32x32x16_bf16 v[4:19], v[216:219], v[108:111], v[4:19]
    s_add_u32 s72, s80, 32768
    buffer_load_dwordx4 v[92:95], v0, s[60:63], s72 offen offset:0 sc1
    s_add_u32 s72, s81, 32768
    buffer_load_dwordx4 v[204:207], v0, s[60:63], s72 offen offset:0 sc1
    v_mfma_f32_32x32x16_bf16 v[20:35], v[220:223], v[108:111], v[20:35]
    s_waitcnt vmcnt(8)
    v_max_u32 v3, v116, v120
    v_cmp_eq_u32 vcc, -1, v3
    v_mfma_f32_32x32x16_bf16 v[36:51], v[216:219], v[112:115], v[36:51]
    s_add_u32 s72, s80, 32768
    buffer_load_dwordx4 v[96:99], v0, s[60:63], s72 offen offset:1024 sc1
    s_add_u32 s72, s81, 32768
    buffer_load_dwordx4 v[208:211], v0, s[60:63], s72 offen offset:1024 sc1
    v_mfma_f32_32x32x16_bf16 v[52:67], v[220:223], v[112:115], v[52:67]
    s_cbranch_vccnz L_bc_44r
L_bc_44:
    v_mfma_f32_32x32x16_bf16 v[4:19], v[224:227], v[116:119], v[4:19]
    s_add_u32 s72, s80, 32768
    buffer_load_dwordx4 v[100:103], v0, s[60:63], s72 offen offset:2048 sc1
    s_add_u32 s72, s81, 32768
    buffer_load_dwordx4 v[212:215], v0, s[60:63], s72 offen offset:2048 sc1
    v_mfma_f32_32x32x16_bf16 v[20:35], v[228:231], v[116:119], v[20:35]
    s_waitcnt vmcnt(10)
    v_max_u32 v3, v124, v192
    v_cmp_eq_u32 vcc, -1, v3
    v_mfma_f32_32x32x16_bf16 v[36:51], v[224:227], v[120:123], v[36:51]
    s_add_u32 s72, s80, 32768
    buffer_load_dwordx4 v[104:107], v0, s[60:63], s72 offen offset:3072 sc1
    s_add_u32 s72, s81, 32768
    buffer_load_dwordx4 v[216:219], v0, s[60:63], s72 offen offset:3072 sc1
    v_mfma_f32_32x32x16_bf16 v[52:67], v[228:231], v[120:123], v[52:67]
    s_cbranch_vccnz L_bc_45r
L_bc_45:
    v_mfma_f32_32x32x16_bf16 v[4:19], v[232:235], v[124:127], v[4:19]
    s_add_u32 s72, s80, 36864
    buffer_load_dwordx4 v[108:111], v0, s[60:63], s72 offen offset:0 sc1
    s_add_u32 s72, s81, 36864
    buffer_load_dwordx4 v[220:223], v0, s[60:63], s72 offen offset:0 sc1
    v_mfma_f32_32x32x16_bf16 v[20:35], v[236:239], v[124:127], v[20:35]
    s_waitcnt vmcnt(12)
    v_max_u32 v3, v84, v196
    v_cmp_eq_u32 vcc, -1, v3
    v_mfma_f32_32x32x16_bf16 v[36:51], v[232:235], v[192:195], v[36:51]
    s_add_u32 s72, s80, 36864
    buffer_load_dwordx4 v[112:115], v0, s[60:63], s72 offen offset:1024 sc1
    s_add_u32 s72, s81, 36864
    buffer_load_dwordx4 v[224:227], v0, s[60:63], s72 offen offset:1024 sc1
    v_mfma_f32_32x32x16_bf16 v[52:67], v[236:239], v[192:195], v[52:67]
    s_cbranch_vccnz L_bc_46r
L_bc_46:
    v_mfma_f32_32x32x16_bf16 v[4:19], v[240:243], v[84:87], v[4:19]
    s_add_u32 s72, s80, 36864
    buffer_load_dwordx4 v[116:119], v0, s[60:63], s72 offen offset:2048 sc1
    s_add_u32 s72, s81, 36864
    buffer_load_dwordx4 v[228:231], v0, s[60:63], s72 offen offset:2048 sc1
    v_mfma_f32_32x32x16_bf16 v[20:35], v[244:247], v[84:87], v[20:35]
    s_waitcnt vmcnt(14)
    v_max_u32 v3, v88, v200
    v_cmp_eq_u32 vcc, -1, v3
    v_mfma_f32_32x32x16_bf16 v[36:51], v[240:243], v[196:199], v[36:51]
    s_add_u32 s72, s80, 36864
    buffer_load_dwordx4 v[120:123], v0, s[60:63], s72 offen offset:3072 sc1
    s_add_u32 s72, s81, 36864
    buffer_load_dwordx4 v[232:235], v0, s[60:63], s72 offen offset:3072 sc1
    v_mfma_f32_32x32x16_bf16 v[52:67], v[244:247], v[196:199], v[52:67]
    s_cbranch_vccnz L_bc_47r
L_bc_47:
    v_mfma_f32_32x32x16_bf16 v[4:19], v[248:251], v[88:91], v[4:19]
    ds_read_b128 v[124:127], v2 offset:0
    ds_read_b128 v[236:239], v2 offset:4096
    v_mfma_f32_32x32x16_bf16 v[20:35], v[252:255], v[88:91], v[20:35]
    s_waitcnt vmcnt(14)
    v_max_u32 v3, v92, v204
    v_cmp_eq_u32 vcc, -1, v3
    v_mfma_f32_32x32x16_bf16 v[36:51], v[248:251], v[200:203], v[36:51]
    ds_read_b128 v[192:195], v2 offset:1024
    v_mfma_f32_32x32x16_bf16 v[52:67], v[252:255], v[200:203], v[52:67]
    s_cbranch_vccnz L_bc_48r
L_bc_48:
    v_mfma_f32_32x32x16_bf16 v[4:19], v[128:131], v[92:95], v[4:19]
    ds_read_b128 v[240:243], v2 offset:5120
    ds_read_b128 v[84:87], v2 offset:2048
    v_mfma_f32_32x32x16_bf16 v[20:35], v[132:135], v[92:95], v[20:35]
    s_waitcnt vmcnt(12)
    v_max_u32 v3, v96, v208
    v_cmp_eq_u32 vcc, -1, v3
    v_mfma_f32_32x32x16_bf16 v[36:51], v[128:131], v[204:207], v[36:51]
    ds_read_b128 v[244:247], v2 offset:6144
    ds_read_b128 v[196:199], v2 offset:3072
    v_mfma_f32_32x32x16_bf16 v[52:67], v[132:135], v[204:207], v[52:67]
    s_cbranch_vccnz L_bc_49r
L_bc_49:
    v_mfma_f32_32x32x16_bf16 v[4:19], v[136:139], v[96:99], v[4:19]
    ds_read_b128 v[248:251], v2 offset:7168
    s_add_u32 s72, s80, s83
    buffer_load_dwordx4 v[88:91], v0, s[60:63], s72 offen offset:0 sc1
    v_mfma_f32_32x32x16_bf16 v[20:35], v[140:143], v[96:99], v[20:35]
    s_waitcnt vmcnt(11)
    v_max_u32 v3, v100, v212
    v_cmp_eq_u32 vcc, -1, v3
    v_mfma_f32_32x32x16_bf16 v[36:51], v[136:139], v[208:211], v[36:51]
    s_add_u32 s72, s80, s83
    buffer_load_dwordx4 v[252:255], v0, s[60:63], s72 offen offset:1024 sc1
    s_add_u32 s72, s80, s83
    buffer_load_dwordx4 v[200:203], v0, s[60:63], s72 offen offset:2048 sc1
    v_mfma_f32_32x32x16_bf16 v[52:67], v[140:143], v[208:211], v[52:67]
    s_cbranch_vccnz L_bc_50r
L_bc_50:
    v_mfma_f32_32x32x16_bf16 v[4:19], v[144:147], v[100:103], v[4:19]
    s_add_u32 s72, s80, s83
    buffer_load_dwordx4 v[128:131], v0, s[60:63], s72 offen offset:3072 sc1
    s_add_u32 s72, s80, s82
    buffer_load_dwordx4 v[92:95], v0, s[60:63], s72 offen offset:0 sc1
    v_mfma_f32_32x32x16_bf16 v[20:35], v[148:151], v[100:103], v[20:35]
    s_waitcnt vmcnt(13)
    v_max_u32 v3, v104, v216
    v_cmp_eq_u32 vcc, -1, v3
    v_mfma_f32_32x32x16_bf16 v[36:51], v[144:147], v[212:215], v[36:51]
    s_add_u32 s72, s80, s82
    buffer_load_dwordx4 v[132:135], v0, s[60:63], s72 offen offset:1024 sc1
    s_add_u32 s72, s81, s83
    buffer_load_dwordx4 v[204:207], v0, s[60:63], s72 offen offset:0 sc1
    v_mfma_f32_32x32x16_bf16 v[52:67], v[148:151], v[212:215], v[52:67]
    s_cbranch_vccnz L_bc_51r
L_bc_51:
    v_mfma_f32_32x32x16_bf16 v[4:19], v[152:155], v[104:107], v[4:19]
    s_add_u32 s72, s81, s83
    buffer_load_dwordx4 v[136:139], v0, s[60:63], s72 offen offset:1024 sc1
    s_add_u32 s72, s81, s83
    buffer_load_dwordx4 v[96:99], v0, s[60:63], s72 offen offset:2048 sc1
    v_mfma_f32_32x32x16_bf16 v[20:35], v[156:159], v[104:107], v[20:35]
    s_waitcnt vmcnt(15)
    v_max_u32 v3, v108, v220
    v_cmp_eq_u32 vcc, -1, v3
    v_mfma_f32_32x32x16_bf16 v[36:51], v[152:155], v[216:219], v[36:51]
    s_add_u32 s72, s81, s83
    buffer_load_dwordx4 v[140:143], v0, s[60:63], s72 offen offset:3072 sc1
    s_add_u32 s72, s81, s82
    buffer_load_dwordx4 v[208:211], v0, s[60:63], s72 offen offset:0 sc1
    v_mfma_f32_32x32x16_bf16 v[52:67], v[156:159], v[216:219], v[52:67]
    s_cbranch_vccnz L_bc_52r
L_bc_52:
    v_mov_b32 v1, 132116
    ds_read_b32 v1, v1
    v_mfma_f32_32x32x16_bf16 v[4:19], v[160:163], v[108:111], v[4:19]
    s_add_u32 s72, s81, s82
    buffer_load_dwordx4 v[144:147], v0, s[60:63], s72 offen offset:1024 sc1
    v_mfma_f32_32x32x16_bf16 v[20:35], v[164:167], v[108:111], v[20:35]
    s_waitcnt vmcnt(16)
    v_max_u32 v3, v112, v224
    v_cmp_eq_u32 vcc, -1, v3
    v_mfma_f32_32x32x16_bf16 v[36:51], v[160:163], v[220:223], v[36:51]
    v_mfma_f32_32x32x16_bf16 v[52:67], v[164:167], v[220:223], v[52:67]
    s_cbranch_vccnz L_bc_53r
L_bc_53:
    v_mfma_f32_32x32x16_bf16 v[4:19], v[168:171], v[112:115], v[4:19]
    v_mfma_f32_32x32x16_bf16 v[20:35], v[172:175], v[112:115], v[20:35]
    s_waitcnt vmcnt(14)
    v_max_u32 v3, v116, v228
    v_cmp_eq_u32 vcc, -1, v3
    v_mfma_f32_32x32x16_bf16 v[36:51], v[168:171], v[224:227], v[36:51]
    v_mfma_f32_32x32x16_bf16 v[52:67], v[172:175], v[224:227], v[52:67]
    s_cbranch_vccnz L_bc_54r
L_bc_54:
    s_waitcnt lgkmcnt(0)
    v_readfirstlane_b32 s74, v1
    s_mul_i32 s73, s69, 17408
    v_add_u32 v1, s73, v0
    v_mfma_f32_32x32x16_bf16 v[4:19], v[176:179], v[116:119], v[4:19]
    v_mfma_f32_32x32x16_bf16 v[20:35], v[180:183], v[116:119], v[20:35]
    s_waitcnt vmcnt(12)
    v_max_u32 v3, v120, v232
    v_cmp_eq_u32 vcc, -1, v3
    v_mfma_f32_32x32x16_bf16 v[36:51], v[176:179], v[228:231], v[36:51]
    v_mfma_f32_32x32x16_bf16 v[52:67], v[180:183], v[228:231], v[52:67]
    s_cbranch_vccnz L_bc_55r
L_bc_55:
    v_mfma_f32_32x32x16_bf16 v[4:19], v[184:187], v[120:123], v[4:19]
    v_mfma_f32_32x32x16_bf16 v[20:35], v[188:191], v[120:123], v[20:35]
    s_waitcnt vmcnt(6)
    v_max_u32 v3, v88, v252
    v_max3_u32 v3, v3, v200, v128
    v_max3_u32 v3, v3, v92, v132
    v_cmp_eq_u32 vcc, -1, v3
    v_mfma_f32_32x32x16_bf16 v[36:51], v[184:187], v[232:235], v[36:51]
    v_mfma_f32_32x32x16_bf16 v[52:67], v[188:191], v[232:235], v[52:67]
    s_cbranch_vccnz L_bc_56r
L_bc_56:
    s_waitcnt lgkmcnt(0)
    v_mfma_f32_32x32x16_bf16 v[4:19], v[124:127], v[88:91], v[4:19]
    v_mfma_f32_32x32x16_bf16 v[4:19], v[192:195], v[252:255], v[4:19]
    v_mfma_f32_32x32x16_bf16 v[4:19], v[84:87], v[200:203], v[4:19]
    v_mfma_f32_32x32x16_bf16 v[4:19], v[196:199], v[128:131], v[4:19]
    v_mfma_f32_32x32x16_bf16 v[4:19], v[68:71], v[92:95], v[4:19]
    s_cmp_ge_u32 s74, 4
    s_cbranch_scc0 L_f2_w1
L_f2_w1b:
    v_mfma_f32_32x32x16_bf16 v[4:19], v[76:79], v[132:135], v[4:19]
    v_mfma_f32_32x32x16_bf16 v[20:35], v[236:239], v[88:91], v[20:35]
    s_waitcnt vmcnt(0)
    v_max_u32 v3, v204, v136
    v_max3_u32 v3, v3, v96, v140
    v_max3_u32 v3, v3, v208, v144
    v_cmp_eq_u32 vcc, -1, v3
    v_mfma_f32_32x32x16_bf16 v[20:35], v[240:243], v[252:255], v[20:35]
    v_mfma_f32_32x32x16_bf16 v[20:35], v[244:247], v[200:203], v[20:35]
    s_nop 3
    ds_write_b128 v1, v[4:7] offset:0
    v_mfma_f32_32x32x16_bf16 v[20:35], v[248:251], v[128:131], v[20:35]
    ds_write_b128 v1, v[8:11] offset:1088
    v_mfma_f32_32x32x16_bf16 v[20:35], v[72:75], v[92:95], v[20:35]
    ds_write_b128 v1, v[12:15] offset:2176
    v_mfma_f32_32x32x16_bf16 v[20:35], v[80:83], v[132:135], v[20:35]
    s_cbranch_vccnz L_bc_57r
L_bc_57:
    ds_write_b128 v1, v[16:19] offset:3264
    v_mfma_f32_32x32x16_bf16 v[36:51], v[124:127], v[204:207], v[36:51]
    v_mfma_f32_32x32x16_bf16 v[36:51], v[192:195], v[136:139], v[36:51]
    v_mfma_f32_32x32x16_bf16 v[36:51], v[84:87], v[96:99], v[36:51]
    s_nop 6
    ds_write_b128 v1, v[20:23] offset:4352
    v_mfma_f32_32x32x16_bf16 v[36:51], v[196:199], v[140:143], v[36:51]
    ds_write_b128 v1, v[24:27] offset:5440
    v_mfma_f32_32x32x16_bf16 v[36:51], v[68:71], v[208:211], v[36:51]
    ds_write_b128 v1, v[28:31] offset:6528
    v_mfma_f32_32x32x16_bf16 v[36:51], v[76:79], v[144:147], v[36:51]
    ds_write_b128 v1, v[32:35] offset:7616
    v_mfma_f32_32x32x16_bf16 v[52:67], v[236:239], v[204:207], v[52:67]
    v_mfma_f32_32x32x16_bf16 v[52:67], v[240:243], v[136:139], v[52:67]
    v_mfma_f32_32x32x16_bf16 v[52:67], v[244:247], v[96:99], v[52:67]
    s_nop 7
    ds_write_b128 v1, v[36:39] offset:8704
    v_mfma_f32_32x32x16_bf16 v[52:67], v[248:251], v[140:143], v[52:67]
    ds_write_b128 v1, v[40:43] offset:9792
    v_mfma_f32_32x32x16_bf16 v[52:67], v[72:75], v[208:211], v[52:67]
    ds_write_b128 v1, v[44:47] offset:10880
    v_mfma_f32_32x32x16_bf16 v[52:67], v[80:83], v[144:147], v[52:67]
    ds_write_b128 v1, v[48:51] offset:11968
    s_nop 10
    ds_write_b128 v1, v[52:55] offset:13056
    ds_write_b128 v1, v[56:59] offset:14144
    ds_write_b128 v1, v[60:63] offset:15232
    ds_write_b128 v1, v[64:67] offset:16320
L_final:
    v_lshrrev_b32 v68, 7, v0
    v_bfe_u32 v69, v0, 4, 3
    s_lshl_b32 s72, s67, 3
    s_add_u32 s72, s72, s64
    s_lshl_b32 s74, s72, 13
    s_lshl_b32 s75, s66, 7
    s_add_u32 s74, s74, s75
    v_lshlrev_b32 v70, 10, v68
    v_lshl_add_u32 v70, v69, 4, v70
    buffer_load_dwordx4 v[120:123], v70, s[56:59], s74 offen sc1
    s_lshl_b32 s75, s66, 8
    s_add_u32 s75, s75, 159744
    v_lshlrev_b32 v71, 5, v69
    v_add_u32 v71, s75, v71
    ds_read_b128 v[80:83], v71
    ds_read_b128 v[84:87], v71 offset:16
    v_mul_u32_u24 v69, 1088, v69
    v_lshl_add_u32 v69, v68, 4, v69
    s_lshr_b32 s75, s64, 2
    s_mul_i32 s75, s75, 8704
    s_lshl_b32 s77, s69, 7
    s_add_u32 s75, s75, s77
    v_add_u32 v69, s75, v69
    s_waitcnt lgkmcnt(0)
    s_barrier
    ds_read_b128 v[88:91], v69 offset:0
    ds_read_b128 v[92:95], v69 offset:512
    ds_read_b128 v[96:99], v69 offset:17408
    ds_read_b128 v[100:103], v69 offset:17920
    ds_read_b128 v[104:107], v69 offset:34816
    ds_read_b128 v[108:111], v69 offset:35328
    ds_read_b128 v[112:115], v69 offset:52224
    ds_read_b128 v[116:119], v69 offset:52736
    s_waitcnt vmcnt(0)
    v_lshlrev_b32 v72, 16, v120
    v_and_b32 v73, 0xffff0000, v120
    v_lshlrev_b32 v74, 16, v121
    v_and_b32 v75, 0xffff0000, v121
    v_lshlrev_b32 v76, 16, v122
    v_and_b32 v77, 0xffff0000, v122
    v_lshlrev_b32 v78, 16, v123
    v_and_b32 v79, 0xffff0000, v123
    s_waitcnt lgkmcnt(4)
    v_pk_add_f32 v[88:89], v[88:89], v[96:97]
    v_pk_add_f32 v[90:91], v[90:91], v[98:99]
    v_pk_add_f32 v[92:93], v[92:93], v[100:101]
    v_pk_add_f32 v[94:95], v[94:95], v[102:103]
    s_waitcnt lgkmcnt(0)
    v_pk_add_f32 v[104:105], v[104:105], v[112:113]
    v_pk_add_f32 v[106:107], v[106:107], v[114:115]
    v_pk_add_f32 v[108:109], v[108:109], v[116:117]
    v_pk_add_f32 v[110:111], v[110:111], v[118:119]
    v_pk_add_f32 v[88:89], v[88:89], v[104:105]
    v_pk_add_f32 v[90:91], v[90:91], v[106:107]
    v_pk_add_f32 v[92:93], v[92:93], v[108:109]
    v_pk_add_f32 v[94:95], v[94:95], v[110:111]
    v_pk_fma_f32 v[88:89], v[88:89], v[80:81], v[72:73]
    v_pk_fma_f32 v[90:91], v[90:91], v[82:83], v[74:75]
    v_pk_fma_f32 v[92:93], v[92:93], v[84:85], v[76:77]
    v_pk_fma_f32 v[94:95], v[94:95], v[86:87], v[78:79]
    v_cvt_pk_bf16_f32 v72, v88, v89
    v_cvt_pk_bf16_f32 v73, v90, v91
    v_cvt_pk_bf16_f32 v74, v92, v93
    v_cvt_pk_bf16_f32 v75, v94, v95
    buffer_store_dwordx4 v[72:75], v70, s[56:59], s74 offen
L_end:
    s_mov_b64 exec, -1
    s_or_b32 s72, s2, s64
    s_cmp_eq_u32 s72, 0
    s_cbranch_scc0 L_noep
    v_mov_b32 v4, s70
    s_mov_b64 exec, 1
    buffer_store_dword v4, v0, s[60:63], 0 offen sc1
    s_mov_b64 exec, -1
L_noep:
L_exit:
    s_endpgm
L_codeend:
L_gretry1:
    buffer_load_dwordx4 v[72:75], v1, s[60:63], s81 offen offset:0 sc1
    buffer_load_dwordx4 v[144:147], v3, s[60:63], s81 offen offset:0 sc1
    buffer_load_dwordx4 v[148:151], v3, s[60:63], s81 offen offset:1280 sc1
    buffer_load_dwordx4 v[76:79], v1, s[60:63], s81 offen offset:2560 sc1
    buffer_load_dwordx4 v[152:155], v3, s[60:63], s81 offen offset:2560 sc1
    buffer_load_dwordx4 v[156:159], v3, s[60:63], s81 offen offset:3840 sc1
    s_add_u32 s29, s29, 1
    s_cmp_gt_u32 s29, 1048576
    s_cbranch_scc1 L_end
    s_waitcnt vmcnt(0)
    v_max_u32 v8, v72, v76
    v_max3_u32 v8, v8, v144, v148
    v_max3_u32 v8, v8, v152, v156
    v_cmp_eq_u32 vcc, -1, v8
    s_cbranch_vccnz L_gretry1
    v_mfma_f32_32x32x16_bf16 v[32:47], v[72:75], v[4:7], 0
    s_branch L_gok1
L_gretry2:
    buffer_load_dwordx4 v[80:83], v1, s[60:63], s82 offen offset:0 sc1
    buffer_load_dwordx4 v[160:163], v3, s[60:63], s82 offen offset:0 sc1
    buffer_load_dwordx4 v[164:167], v3, s[60:63], s82 offen offset:1280 sc1
    buffer_load_dwordx4 v[84:87], v1, s[60:63], s82 offen offset:2560 sc1
    buffer_load_dwordx4 v[168:171], v3, s[60:63], s82 offen offset:2560 sc1
    buffer_load_dwordx4 v[172:175], v3, s[60:63], s82 offen offset:3840 sc1
    s_add_u32 s29, s29, 1
    s_cmp_gt_u32 s29, 1048576
    s_cbranch_scc1 L_end
    s_waitcnt vmcnt(0)
    v_max_u32 v8, v80, v84
    v_max3_u32 v8, v8, v160, v164
    v_max3_u32 v8, v8, v168, v172
    v_cmp_eq_u32 vcc, -1, v8
    s_cbranch_vccnz L_gretry2
    v_mfma_f32_32x32x16_bf16 v[32:47], v[80:83], v[4:7], 0
    s_branch L_gok2
L_gretry3:
    buffer_load_dwordx4 v[88:91], v1, s[60:63], s83 offen offset:0 sc1
    buffer_load_dwordx4 v[176:179], v3, s[60:63], s83 offen offset:0 sc1
    buffer_load_dwordx4 v[180:183], v3, s[60:63], s83 offen offset:1280 sc1
    buffer_load_dwordx4 v[92:95], v1, s[60:63], s83 offen offset:2560 sc1
    buffer_load_dwordx4 v[184:187], v3, s[60:63], s83 offen offset:2560 sc1
    buffer_load_dwordx4 v[188:191], v3, s[60:63], s83 offen offset:3840 sc1
    s_add_u32 s29, s29, 1
    s_cmp_gt_u32 s29, 1048576
    s_cbranch_scc1 L_end
    s_waitcnt vmcnt(0)
    v_max_u32 v8, v88, v92
    v_max3_u32 v8, v8, v176, v180
    v_max3_u32 v8, v8, v184, v188
    v_cmp_eq_u32 vcc, -1, v8
    s_cbranch_vccnz L_gretry3
    v_mfma_f32_32x32x16_bf16 v[32:47], v[88:91], v[4:7], 0
    s_branch L_gok3
L_gretry4:
    buffer_load_dwordx4 v[96:99], v1, s[60:63], s84 offen offset:0 sc1
    buffer_load_dwordx4 v[192:195], v3, s[60:63], s84 offen offset:0 sc1
    buffer_load_dwordx4 v[196:199], v3, s[60:63], s84 offen offset:1280 sc1
    buffer_load_dwordx4 v[100:103], v1, s[60:63], s84 offen offset:2560 sc1
    buffer_load_dwordx4 v[200:203], v3, s[60:63], s84 offen offset:2560 sc1
    buffer_load_dwordx4 v[204:207], v3, s[60:63], s84 offen offset:3840 sc1
    s_add_u32 s29, s29, 1
    s_cmp_gt_u32 s29, 1048576
    s_cbranch_scc1 L_end
    s_waitcnt vmcnt(0)
    v_max_u32 v8, v96, v100
    v_max3_u32 v8, v8, v192, v196
    v_max3_u32 v8, v8, v200, v204
    v_cmp_eq_u32 vcc, -1, v8
    s_cbranch_vccnz L_gretry4
    v_mfma_f32_32x32x16_bf16 v[32:47], v[96:99], v[4:7], 0
    s_branch L_gok4
L_gretry5:
    buffer_load_dwordx4 v[104:107], v1, s[60:63], s85 offen offset:0 sc1
    buffer_load_dwordx4 v[208:211], v3, s[60:63], s85 offen offset:0 sc1
    buffer_load_dwordx4 v[212:215], v3, s[60:63], s85 offen offset:1280 sc1
    buffer_load_dwordx4 v[108:111], v1, s[60:63], s85 offen offset:2560 sc1
    buffer_load_dwordx4 v[216:219], v3, s[60:63], s85 offen offset:2560 sc1
    buffer_load_dwordx4 v[220:223], v3, s[60:63], s85 offen offset:3840 sc1
    s_add_u32 s29, s29, 1
    s_cmp_gt_u32 s29, 1048576
    s_cbranch_scc1 L_end
    s_waitcnt vmcnt(0)
    v_max_u32 v8, v104, v108
    v_max3_u32 v8, v8, v208, v212
    v_max3_u32 v8, v8, v216, v220
    v_cmp_eq_u32 vcc, -1, v8
    s_cbranch_vccnz L_gretry5
    v_mfma_f32_32x32x16_bf16 v[32:47], v[104:107], v[4:7], 0
    s_branch L_gok5
L_gretry6:
    buffer_load_dwordx4 v[112:115], v1, s[60:63], s86 offen offset:0 sc1
    buffer_load_dwordx4 v[224:227], v3, s[60:63], s86 offen offset:0 sc1
    buffer_load_dwordx4 v[228:231], v3, s[60:63], s86 offen offset:1280 sc1
    buffer_load_dwordx4 v[116:119], v1, s[60:63], s86 offen offset:2560 sc1
    buffer_load_dwordx4 v[232:235], v3, s[60:63], s86 offen offset:2560 sc1
    buffer_load_dwordx4 v[236:239], v3, s[60:63], s86 offen offset:3840 sc1
    s_add_u32 s29, s29, 1
    s_cmp_gt_u32 s29, 1048576
    s_cbranch_scc1 L_end
    s_waitcnt vmcnt(0)
    v_max_u32 v8, v112, v116
    v_max3_u32 v8, v8, v224, v228
    v_max3_u32 v8, v8, v232, v236
    v_cmp_eq_u32 vcc, -1, v8
    s_cbranch_vccnz L_gretry6
    v_mfma_f32_32x32x16_bf16 v[32:47], v[112:115], v[4:7], 0
    s_branch L_gok6
L_gretry7:
    buffer_load_dwordx4 v[120:123], v1, s[60:63], s87 offen offset:0 sc1
    buffer_load_dwordx4 v[240:243], v3, s[60:63], s87 offen offset:0 sc1
    buffer_load_dwordx4 v[244:247], v3, s[60:63], s87 offen offset:1280 sc1
    buffer_load_dwordx4 v[124:127], v1, s[60:63], s87 offen offset:2560 sc1
    buffer_load_dwordx4 v[248:251], v3, s[60:63], s87 offen offset:2560 sc1
    buffer_load_dwordx4 v[252:255], v3, s[60:63], s87 offen offset:3840 sc1
    s_add_u32 s29, s29, 1
    s_cmp_gt_u32 s29, 1048576
    s_cbranch_scc1 L_end
    s_waitcnt vmcnt(0)
    v_max_u32 v8, v120, v124
    v_max3_u32 v8, v8, v240, v244
    v_max3_u32 v8, v8, v248, v252
    v_cmp_eq_u32 vcc, -1, v8
    s_cbranch_vccnz L_gretry7
    v_mfma_f32_32x32x16_bf16 v[32:47], v[120:123], v[4:7], 0
    s_branch L_gok7
L_qwaita:
    s_sleep 1
    ds_read_b128 v[4:7], v2
    s_add_u32 s98, s98, 1
    s_cmp_gt_u32 s98, 1048576
    s_cbranch_scc1 L_end
    s_waitcnt lgkmcnt(0)
    v_cmp_eq_u32 vcc, -1, v4
    s_cbranch_vccnz L_qwaita
    s_branch L_qoka
L_await0:
    s_sleep 1
    ds_read_b32 v8, v1
    s_add_u32 s98, s98, 1
    s_cmp_gt_u32 s98, 1048576
    s_cbranch_scc1 L_end
    s_waitcnt lgkmcnt(0)
    v_cmp_ne_u32 vcc, -1, v8
    s_cbranch_vccnz L_await0
    ds_read_b128 v[4:7], v2 offset:0
    s_branch L_aok0
L_f1_ldw:
    v_mov_b32 v5, 132496
    ds_read_b32 v5, v5
    s_add_u32 s98, s98, 1
    s_cmp_gt_u32 s98, 1048576
    s_cbranch_scc1 L_end
    s_waitcnt lgkmcnt(0)
    s_branch L_f1_ld
L_pollx:
    buffer_load_dword v17, v16, s[60:63], s88 offen sc1
    s_add_u32 s98, s98, 1
    s_cmp_gt_u32 s98, 1048576
    s_cbranch_scc1 L_end
    s_waitcnt vmcnt(0)
    s_branch L_xchk
L_bc_40r:
    s_add_u32 s29, s29, 1
    s_add_u32 s72, s80, 0
    buffer_load_dwordx4 v[84:87], v0, s[60:63], s72 offen offset:0 sc1
    s_add_u32 s72, s81, 0
    buffer_load_dwordx4 v[88:91], v0, s[60:63], s72 offen offset:0 sc1
    s_add_u32 s72, s80, 0
    buffer_load_dwordx4 v[92:95], v0, s[60:63], s72 offen offset:1024 sc1
    s_add_u32 s72, s81, 0
    buffer_load_dwordx4 v[96:99], v0, s[60:63], s72 offen offset:1024 sc1
    s_add_u32 s72, s80, 0
    buffer_load_dwordx4 v[100:103], v0, s[60:63], s72 offen offset:2048 sc1
    s_add_u32 s72, s81, 0
    buffer_load_dwordx4 v[104:107], v0, s[60:63], s72 offen offset:2048 sc1
    s_add_u32 s72, s80, 0
    buffer_load_dwordx4 v[108:111], v0, s[60:63], s72 offen offset:3072 sc1
    s_add_u32 s72, s81, 0
    buffer_load_dwordx4 v[112:115], v0, s[60:63], s72 offen offset:3072 sc1
    s_add_u32 s98, s98, 1
    s_cmp_gt_u32 s98, 1048576
    s_cbranch_scc1 L_end
    s_waitcnt vmcnt(0)
    v_max_u32 v3, v84, v88
    v_cmp_eq_u32 vcc, -1, v3
    s_cbranch_vccnz L_bc_40r
    s_branch L_bc_40
L_bc_41r:
    s_add_u32 s29, s29, 1
    s_add_u32 s72, s80, 0
    buffer_load_dwordx4 v[92:95], v0, s[60:63], s72 offen offset:1024 sc1
    s_add_u32 s72, s81, 0
    buffer_load_dwordx4 v[96:99], v0, s[60:63], s72 offen offset:1024 sc1
    s_add_u32 s72, s80, 0
    buffer_load_dwordx4 v[100:103], v0, s[60:63], s72 offen offset:2048 sc1
    s_add_u32 s72, s81, 0
    buffer_load_dwordx4 v[104:107], v0, s[60:63], s72 offen offset:2048 sc1
    s_add_u32 s72, s80, 0
    buffer_load_dwordx4 v[108:111], v0, s[60:63], s72 offen offset:3072 sc1
    s_add_u32 s72, s81, 0
    buffer_load_dwordx4 v[112:115], v0, s[60:63], s72 offen offset:3072 sc1
    s_add_u32 s72, s80, 4096
    buffer_load_dwordx4 v[116:119], v0, s[60:63], s72 offen offset:0 sc1
    s_add_u32 s72, s81, 4096
    buffer_load_dwordx4 v[120:123], v0, s[60:63], s72 offen offset:0 sc1
    s_add_u32 s72, s80, 4096
    buffer_load_dwordx4 v[124:127], v0, s[60:63], s72 offen offset:1024 sc1
    s_add_u32 s98, s98, 1
    s_cmp_gt_u32 s98, 1048576
    s_cbranch_scc1 L_end
    s_waitcnt vmcnt(0)
    v_max_u32 v3, v92, v96
    v_cmp_eq_u32 vcc, -1, v3
    s_cbranch_vccnz L_bc_41r
    s_branch L_bc_41
L_bc_42r:
    s_add_u32 s29, s29, 1
    s_add_u32 s72, s80, 0
    buffer_load_dwordx4 v[100:103], v0, s[60:63], s72 offen offset:2048 sc1
    s_add_u32 s72, s81, 0
    buffer_load_dwordx4 v[104:107], v0, s[60:63], s72 offen offset:2048 sc1
    s_add_u32 s72, s80, 0
    buffer_load_dwordx4 v[108:111], v0, s[60:63], s72 offen offset:3072 sc1
    s_add_u32 s72, s81, 0
    buffer_load_dwordx4 v[112:115], v0, s[60:63], s72 offen offset:3072 sc1
    s_add_u32 s72, s80, 4096
    buffer_load_dwordx4 v[116:119], v0, s[60:63], s72 offen offset:0 sc1
    s_add_u32 s72, s81, 4096
    buffer_load_dwordx4 v[120:123], v0, s[60:63], s72 offen offset:0 sc1
    s_add_u32 s72, s80, 4096
    buffer_load_dwordx4 v[124:127], v0, s[60:63], s72 offen offset:1024 sc1
    s_add_u32 s72, s81, 4096
    buffer_load_dwordx4 v[192:195], v0, s[60:63], s72 offen offset:1024 sc1
    s_add_u32 s72, s80, 4096
    buffer_load_dwordx4 v[84:87], v0, s[60:63], s72 offen offset:2048 sc1
    s_add_u32 s72, s81, 4096
    buffer_load_dwordx4 v[196:199], v0, s[60:63], s72 offen offset:2048 sc1
    s_add_u32 s72, s80, 4096
    buffer_load_dwordx4 v[88:91], v0, s[60:63], s72 offen offset:3072 sc1
    s_add_u32 s98, s98, 1
    s_cmp_gt_u32 s98, 1048576
    s_cbranch_scc1 L_end
    s_waitcnt vmcnt(0)
    v_max_u32 v3, v100, v104
    v_cmp_eq_u32 vcc, -1, v3
    s_cbranch_vccnz L_bc_42r
    s_branch L_bc_42
L_bc_43r:
    s_add_u32 s29, s29, 1
    s_add_u32 s72, s80, 0
    buffer_load_dwordx4 v[108:111], v0, s[60:63], s72 offen offset:3072 sc1
    s_add_u32 s72, s81, 0
    buffer_load_dwordx4 v[112:115], v0, s[60:63], s72 offen offset:3072 sc1
    s_add_u32 s72, s80, 4096
    buffer_load_dwordx4 v[116:119], v0, s[60:63], s72 offen offset:0 sc1
    s_add_u32 s72, s81, 4096
    buffer_load_dwordx4 v[120:123], v0, s[60:63], s72 offen offset:0 sc1
    s_add_u32 s72, s80, 4096
    buffer_load_dwordx4 v[124:127], v0, s[60:63], s72 offen offset:1024 sc1
    s_add_u32 s72, s81, 4096
    buffer_load_dwordx4 v[192:195], v0, s[60:63], s72 offen offset:1024 sc1
    s_add_u32 s72, s80, 4096
    buffer_load_dwordx4 v[84:87], v0, s[60:63], s72 offen offset:2048 sc1
    s_add_u32 s72, s81, 4096
    buffer_load_dwordx4 v[196:199], v0, s[60:63], s72 offen offset:2048 sc1
    s_add_u32 s72, s80, 4096
    buffer_load_dwordx4 v[88:91], v0, s[60:63], s72 offen offset:3072 sc1
    s_add_u32 s72, s81, 4096
    buffer_load_dwordx4 v[200:203], v0, s[60:63], s72 offen offset:3072 sc1
    s_add_u32 s98, s98, 1
    s_cmp_gt_u32 s98, 1048576
    s_cbranch_scc1 L_end
    s_waitcnt vmcnt(0)
    v_max_u32 v3, v108, v112
    v_cmp_eq_u32 vcc, -1, v3
    s_cbranch_vccnz L_bc_43r
    s_branch L_bc_43
L_bc_44r:
    s_add_u32 s29, s29, 1
    s_add_u32 s72, s80, 4096
    buffer_load_dwordx4 v[116:119], v0, s[60:63], s72 offen offset:0 sc1
    s_add_u32 s72, s81, 4096
    buffer_load_dwordx4 v[120:123], v0, s[60:63], s72 offen offset:0 sc1
    s_add_u32 s72, s80, 4096
    buffer_load_dwordx4 v[124:127], v0, s[60:63], s72 offen offset:1024 sc1
    s_add_u32 s72, s81, 4096
    buffer_load_dwordx4 v[192:195], v0, s[60:63], s72 offen offset:1024 sc1
    s_add_u32 s72, s80, 4096
    buffer_load_dwordx4 v[84:87], v0, s[60:63], s72 offen offset:2048 sc1
    s_add_u32 s72, s81, 4096
    buffer_load_dwordx4 v[196:199], v0, s[60:63], s72 offen offset:2048 sc1
    s_add_u32 s72, s80, 4096
    buffer_load_dwordx4 v[88:91], v0, s[60:63], s72 offen offset:3072 sc1
    s_add_u32 s72, s81, 4096
    buffer_load_dwordx4 v[200:203], v0, s[60:63], s72 offen offset:3072 sc1
    s_add_u32 s72, s80, 32768
    buffer_load_dwordx4 v[92:95], v0, s[60:63], s72 offen offset:0 sc1
    s_add_u32 s72, s81, 32768
    buffer_load_dwordx4 v[204:207], v0, s[60:63], s72 offen offset:0 sc1
    s_add_u32 s72, s80, 32768
    buffer_load_dwordx4 v[96:99], v0, s[60:63], s72 offen offset:1024 sc1
    s_add_u32 s72, s81, 32768
    buffer_load_dwordx4 v[208:211], v0, s[60:63], s72 offen offset:1024 sc1
    s_add_u32 s98, s98, 1
    s_cmp_gt_u32 s98, 1048576
    s_cbranch_scc1 L_end
    s_waitcnt vmcnt(0)
    v_max_u32 v3, v116, v120
    v_cmp_eq_u32 vcc, -1, v3
    s_cbranch_vccnz L_bc_44r
    s_branch L_bc_44
L_bc_45r:
    s_add_u32 s29, s29, 1
    s_add_u32 s72, s80, 4096
    buffer_load_dwordx4 v[124:127], v0, s[60:63], s72 offen offset:1024 sc1
    s_add_u32 s72, s81, 4096
    buffer_load_dwordx4 v[192:195], v0, s[60:63], s72 offen offset:1024 sc1
    s_add_u32 s72, s80, 4096
    buffer_load_dwordx4 v[84:87], v0, s[60:63], s72 offen offset:2048 sc1
    s_add_u32 s72, s81, 4096
    buffer_load_dwordx4 v[196:199], v0, s[60:63], s72 offen offset:2048 sc1
    s_add_u32 s72, s80, 4096
    buffer_load_dwordx4 v[88:91], v0, s[60:63], s72 offen offset:3072 sc1
    s_add_u32 s72, s81, 4096
    buffer_load_dwordx4 v[200:203], v0, s[60:63], s72 offen offset:3072 sc1
    s_add_u32 s72, s80, 32768
    buffer_load_dwordx4 v[92:95], v0, s[60:63], s72 offen offset:0 sc1
    s_add_u32 s72, s81, 32768
    buffer_load_dwordx4 v[204:207], v0, s[60:63], s72 offen offset:0 sc1
    s_add_u32 s72, s80, 32768
    buffer_load_dwordx4 v[96:99], v0, s[60:63], s72 offen offset:1024 sc1
    s_add_u32 s72, s81, 32768
    buffer_load_dwordx4 v[208:211], v0, s[60:63], s72 offen offset:1024 sc1
    s_add_u32 s72, s80, 32768
    buffer_load_dwordx4 v[100:103], v0, s[60:63], s72 offen offset:2048 sc1
    s_add_u32 s72, s81, 32768
    buffer_load_dwordx4 v[212:215], v0, s[60:63], s72 offen offset:2048 sc1
    s_add_u32 s72, s80, 32768
    buffer_load_dwordx4 v[104:107], v0, s[60:63], s72 offen offset:3072 sc1
    s_add_u32 s72, s81, 32768
    buffer_load_dwordx4 v[216:219], v0, s[60:63], s72 offen offset:3072 sc1
    s_add_u32 s98, s98, 1
    s_cmp_gt_u32 s98, 1048576
    s_cbranch_scc1 L_end
    s_waitcnt vmcnt(0)
    v_max_u32 v3, v124, v192
    v_cmp_eq_u32 vcc, -1, v3
    s_cbranch_vccnz L_bc_45r
    s_branch L_bc_45
L_bc_46r:
    s_add_u32 s29, s29, 1
    s_add_u32 s72, s80, 4096
    buffer_load_dwordx4 v[84:87], v0, s[60:63], s72 offen offset:2048 sc1
    s_add_u32 s72, s81, 4096
    buffer_load_dwordx4 v[196:199], v0, s[60:63], s72 offen offset:2048 sc1
    s_add_u32 s72, s80, 4096
    buffer_load_dwordx4 v[88:91], v0, s[60:63], s72 offen offset:3072 sc1
    s_add_u32 s72, s81, 4096
    buffer_load_dwordx4 v[200:203], v0, s[60:63], s72 offen offset:3072 sc1
    s_add_u32 s72, s80, 32768
    buffer_load_dwordx4 v[92:95], v0, s[60:63], s72 offen offset:0 sc1
    s_add_u32 s72, s81, 32768
    buffer_load_dwordx4 v[204:207], v0, s[60:63], s72 offen offset:0 sc1
    s_add_u32 s72, s80, 32768
    buffer_load_dwordx4 v[96:99], v0, s[60:63], s72 offen offset:1024 sc1
    s_add_u32 s72, s81, 32768
    buffer_load_dwordx4 v[208:211], v0, s[60:63], s72 offen offset:1024 sc1
    s_add_u32 s72, s80, 32768
    buffer_load_dwordx4 v[100:103], v0, s[60:63], s72 offen offset:2048 sc1
    s_add_u32 s72, s81, 32768
    buffer_load_dwordx4 v[212:215], v0, s[60:63], s72 offen offset:2048 sc1
    s_add_u32 s72, s80, 32768
    buffer_load_dwordx4 v[104:107], v0, s[60:63], s72 offen offset:3072 sc1
    s_add_u32 s72, s81, 32768
    buffer_load_dwordx4 v[216:219], v0, s[60:63], s72 offen offset:3072 sc1
    s_add_u32 s72, s80, 36864
    buffer_load_dwordx4 v[108:111], v0, s[60:63], s72 offen offset:0 sc1
    s_add_u32 s72, s81, 36864
    buffer_load_dwordx4 v[220:223], v0, s[60:63], s72 offen offset:0 sc1
    s_add_u32 s72, s80, 36864
    buffer_load_dwordx4 v[112:115], v0, s[60:63], s72 offen offset:1024 sc1
    s_add_u32 s72, s81, 36864
    buffer_load_dwordx4 v[224:227], v0, s[60:63], s72 offen offset:1024 sc1
    s_add_u32 s98, s98, 1
    s_cmp_gt_u32 s98, 1048576
    s_cbranch_scc1 L_end
    s_waitcnt vmcnt(0)
    v_max_u32 v3, v84, v196
    v_cmp_eq_u32 vcc, -1, v3
    s_cbranch_vccnz L_bc_46r
    s_branch L_bc_46
L_bc_47r:
    s_add_u32 s29, s29, 1
    s_add_u32 s72, s80, 4096
    buffer_load_dwordx4 v[88:91], v0, s[60:63], s72 offen offset:3072 sc1
    s_add_u32 s72, s81, 4096
    buffer_load_dwordx4 v[200:203], v0, s[60:63], s72 offen offset:3072 sc1
    s_add_u32 s72, s80, 32768
    buffer_load_dwordx4 v[92:95], v0, s[60:63], s72 offen offset:0 sc1
    s_add_u32 s72, s81, 32768
    buffer_load_dwordx4 v[204:207], v0, s[60:63], s72 offen offset:0 sc1
    s_add_u32 s72, s80, 32768
    buffer_load_dwordx4 v[96:99], v0, s[60:63], s72 offen offset:1024 sc1
    s_add_u32 s72, s81, 32768
    buffer_load_dwordx4 v[208:211], v0, s[60:63], s72 offen offset:1024 sc1
    s_add_u32 s72, s80, 32768
    buffer_load_dwordx4 v[100:103], v0, s[60:63], s72 offen offset:2048 sc1
    s_add_u32 s72, s81, 32768
    buffer_load_dwordx4 v[212:215], v0, s[60:63], s72 offen offset:2048 sc1
    s_add_u32 s72, s80, 32768
    buffer_load_dwordx4 v[104:107], v0, s[60:63], s72 offen offset:3072 sc1
    s_add_u32 s72, s81, 32768
    buffer_load_dwordx4 v[216:219], v0, s[60:63], s72 offen offset:3072 sc1
    s_add_u32 s72, s80, 36864
    buffer_load_dwordx4 v[108:111], v0, s[60:63], s72 offen offset:0 sc1
    s_add_u32 s72, s81, 36864
    buffer_load_dwordx4 v[220:223], v0, s[60:63], s72 offen offset:0 sc1
    s_add_u32 s72, s80, 36864
    buffer_load_dwordx4 v[112:115], v0, s[60:63], s72 offen offset:1024 sc1
    s_add_u32 s72, s81, 36864
    buffer_load_dwordx4 v[224:227], v0, s[60:63], s72 offen offset:1024 sc1
    s_add_u32 s72, s80, 36864
    buffer_load_dwordx4 v[116:119], v0, s[60:63], s72 offen offset:2048 sc1
    s_add_u32 s72, s81, 36864
    buffer_load_dwordx4 v[228:231], v0, s[60:63], s72 offen offset:2048 sc1
    s_add_u32 s72, s80, 36864
    buffer_load_dwordx4 v[120:123], v0, s[60:63], s72 offen offset:3072 sc1
    s_add_u32 s72, s81, 36864
    buffer_load_dwordx4 v[232:235], v0, s[60:63], s72 offen offset:3072 sc1
    s_add_u32 s98, s98, 1
    s_cmp_gt_u32 s98, 1048576
    s_cbranch_scc1 L_end
    s_waitcnt vmcnt(0)
    v_max_u32 v3, v88, v200
    v_cmp_eq_u32 vcc, -1, v3
    s_cbranch_vccnz L_bc_47r
    s_branch L_bc_47
L_bc_48r:
    s_add_u32 s29, s29, 1
    s_add_u32 s72, s80, 32768
    buffer_load_dwordx4 v[92:95], v0, s[60:63], s72 offen offset:0 sc1
    s_add_u32 s72, s81, 32768
    buffer_load_dwordx4 v[204:207], v0, s[60:63], s72 offen offset:0 sc1
    s_add_u32 s72, s80, 32768
    buffer_load_dwordx4 v[96:99], v0, s[60:63], s72 offen offset:1024 sc1
    s_add_u32 s72, s81, 32768
    buffer_load_dwordx4 v[208:211], v0, s[60:63], s72 offen offset:1024 sc1
    s_add_u32 s72, s80, 32768
    buffer_load_dwordx4 v[100:103], v0, s[60:63], s72 offen offset:2048 sc1
    s_add_u32 s72, s81, 32768
    buffer_load_dwordx4 v[212:215], v0, s[60:63], s72 offen offset:2048 sc1
    s_add_u32 s72, s80, 32768
    buffer_load_dwordx4 v[104:107], v0, s[60:63], s72 offen offset:3072 sc1
    s_add_u32 s72, s81, 32768
    buffer_load_dwordx4 v[216:219], v0, s[60:63], s72 offen offset:3072 sc1
    s_add_u32 s72, s80, 36864
    buffer_load_dwordx4 v[108:111], v0, s[60:63], s72 offen offset:0 sc1
    s_add_u32 s72, s81, 36864
    buffer_load_dwordx4 v[220:223], v0, s[60:63], s72 offen offset:0 sc1
    s_add_u32 s72, s80, 36864
    buffer_load_dwordx4 v[112:115], v0, s[60:63], s72 offen offset:1024 sc1
    s_add_u32 s72, s81, 36864
    buffer_load_dwordx4 v[224:227], v0, s[60:63], s72 offen offset:1024 sc1
    s_add_u32 s72, s80, 36864
    buffer_load_dwordx4 v[116:119], v0, s[60:63], s72 offen offset:2048 sc1
    s_add_u32 s72, s81, 36864
    buffer_load_dwordx4 v[228:231], v0, s[60:63], s72 offen offset:2048 sc1
    s_add_u32 s72, s80, 36864
    buffer_load_dwordx4 v[120:123], v0, s[60:63], s72 offen offset:3072 sc1
    s_add_u32 s72, s81, 36864
    buffer_load_dwordx4 v[232:235], v0, s[60:63], s72 offen offset:3072 sc1
    s_add_u32 s98, s98, 1
    s_cmp_gt_u32 s98, 1048576
    s_cbranch_scc1 L_end
    s_waitcnt vmcnt(0)
    v_max_u32 v3, v92, v204
    v_cmp_eq_u32 vcc, -1, v3
    s_cbranch_vccnz L_bc_48r
    s_branch L_bc_48
L_bc_49r:
    s_add_u32 s29, s29, 1
    s_add_u32 s72, s80, 32768
    buffer_load_dwordx4 v[96:99], v0, s[60:63], s72 offen offset:1024 sc1
    s_add_u32 s72, s81, 32768
    buffer_load_dwordx4 v[208:211], v0, s[60:63], s72 offen offset:1024 sc1
    s_add_u32 s72, s80, 32768
    buffer_load_dwordx4 v[100:103], v0, s[60:63], s72 offen offset:2048 sc1
    s_add_u32 s72, s81, 32768
    buffer_load_dwordx4 v[212:215], v0, s[60:63], s72 offen offset:2048 sc1
    s_add_u32 s72, s80, 32768
    buffer_load_dwordx4 v[104:107], v0, s[60:63], s72 offen offset:3072 sc1
    s_add_u32 s72, s81, 32768
    buffer_load_dwordx4 v[216:219], v0, s[60:63], s72 offen offset:3072 sc1
    s_add_u32 s72, s80, 36864
    buffer_load_dwordx4 v[108:111], v0, s[60:63], s72 offen offset:0 sc1
    s_add_u32 s72, s81, 36864
    buffer_load_dwordx4 v[220:223], v0, s[60:63], s72 offen offset:0 sc1
    s_add_u32 s72, s80, 36864
    buffer_load_dwordx4 v[112:115], v0, s[60:63], s72 offen offset:1024 sc1
    s_add_u32 s72, s81, 36864
    buffer_load_dwordx4 v[224:227], v0, s[60:63], s72 offen offset:1024 sc1
    s_add_u32 s72, s80, 36864
    buffer_load_dwordx4 v[116:119], v0, s[60:63], s72 offen offset:2048 sc1
    s_add_u32 s72, s81, 36864
    buffer_load_dwordx4 v[228:231], v0, s[60:63], s72 offen offset:2048 sc1
    s_add_u32 s72, s80, 36864
    buffer_load_dwordx4 v[120:123], v0, s[60:63], s72 offen offset:3072 sc1
    s_add_u32 s72, s81, 36864
    buffer_load_dwordx4 v[232:235], v0, s[60:63], s72 offen offset:3072 sc1
    s_add_u32 s98, s98, 1
    s_cmp_gt_u32 s98, 1048576
    s_cbranch_scc1 L_end
    s_waitcnt vmcnt(0)
    v_max_u32 v3, v96, v208
    v_cmp_eq_u32 vcc, -1, v3
    s_cbranch_vccnz L_bc_49r
    s_branch L_bc_49
L_bc_50r:
    s_add_u32 s29, s29, 1
    s_add_u32 s72, s80, 32768
    buffer_load_dwordx4 v[100:103], v0, s[60:63], s72 offen offset:2048 sc1
    s_add_u32 s72, s81, 32768
    buffer_load_dwordx4 v[212:215], v0, s[60:63], s72 offen offset:2048 sc1
    s_add_u32 s72, s80, 32768
    buffer_load_dwordx4 v[104:107], v0, s[60:63], s72 offen offset:3072 sc1
    s_add_u32 s72, s81, 32768
    buffer_load_dwordx4 v[216:219], v0, s[60:63], s72 offen offset:3072 sc1
    s_add_u32 s72, s80, 36864
    buffer_load_dwordx4 v[108:111], v0, s[60:63], s72 offen offset:0 sc1
    s_add_u32 s72, s81, 36864
    buffer_load_dwordx4 v[220:223], v0, s[60:63], s72 offen offset:0 sc1
    s_add_u32 s72, s80, 36864
    buffer_load_dwordx4 v[112:115], v0, s[60:63], s72 offen offset:1024 sc1
    s_add_u32 s72, s81, 36864
    buffer_load_dwordx4 v[224:227], v0, s[60:63], s72 offen offset:1024 sc1
    s_add_u32 s72, s80, 36864
    buffer_load_dwordx4 v[116:119], v0, s[60:63], s72 offen offset:2048 sc1
    s_add_u32 s72, s81, 36864
    buffer_load_dwordx4 v[228:231], v0, s[60:63], s72 offen offset:2048 sc1
    s_add_u32 s72, s80, 36864
    buffer_load_dwordx4 v[120:123], v0, s[60:63], s72 offen offset:3072 sc1
    s_add_u32 s72, s81, 36864
    buffer_load_dwordx4 v[232:235], v0, s[60:63], s72 offen offset:3072 sc1
    s_add_u32 s72, s80, s83
    buffer_load_dwordx4 v[88:91], v0, s[60:63], s72 offen offset:0 sc1
    s_add_u32 s72, s80, s83
    buffer_load_dwordx4 v[252:255], v0, s[60:63], s72 offen offset:1024 sc1
    s_add_u32 s72, s80, s83
    buffer_load_dwordx4 v[200:203], v0, s[60:63], s72 offen offset:2048 sc1
    s_add_u32 s98, s98, 1
    s_cmp_gt_u32 s98, 1048576
    s_cbranch_scc1 L_end
    s_waitcnt vmcnt(0)
    v_max_u32 v3, v100, v212
    v_cmp_eq_u32 vcc, -1, v3
    s_cbranch_vccnz L_bc_50r
    s_branch L_bc_50
L_bc_51r:
    s_add_u32 s29, s29, 1
    s_add_u32 s72, s80, 32768
    buffer_load_dwordx4 v[104:107], v0, s[60:63], s72 offen offset:3072 sc1
    s_add_u32 s72, s81, 32768
    buffer_load_dwordx4 v[216:219], v0, s[60:63], s72 offen offset:3072 sc1
    s_add_u32 s72, s80, 36864
    buffer_load_dwordx4 v[108:111], v0, s[60:63], s72 offen offset:0 sc1
    s_add_u32 s72, s81, 36864
    buffer_load_dwordx4 v[220:223], v0, s[60:63], s72 offen offset:0 sc1
    s_add_u32 s72, s80, 36864
    buffer_load_dwordx4 v[112:115], v0, s[60:63], s72 offen offset:1024 sc1
    s_add_u32 s72, s81, 36864
    buffer_load_dwordx4 v[224:227], v0, s[60:63], s72 offen offset:1024 sc1
    s_add_u32 s72, s80, 36864
    buffer_load_dwordx4 v[116:119], v0, s[60:63], s72 offen offset:2048 sc1
    s_add_u32 s72, s81, 36864
    buffer_load_dwordx4 v[228:231], v0, s[60:63], s72 offen offset:2048 sc1
    s_add_u32 s72, s80, 36864
    buffer_load_dwordx4 v[120:123], v0, s[60:63], s72 offen offset:3072 sc1
    s_add_u32 s72, s81, 36864
    buffer_load_dwordx4 v[232:235], v0, s[60:63], s72 offen offset:3072 sc1
    s_add_u32 s72, s80, s83
    buffer_load_dwordx4 v[88:91], v0, s[60:63], s72 offen offset:0 sc1
    s_add_u32 s72, s80, s83
    buffer_load_dwordx4 v[252:255], v0, s[60:63], s72 offen offset:1024 sc1
    s_add_u32 s72, s80, s83
    buffer_load_dwordx4 v[200:203], v0, s[60:63], s72 offen offset:2048 sc1
    s_add_u32 s72, s80, s83
    buffer_load_dwordx4 v[128:131], v0, s[60:63], s72 offen offset:3072 sc1
    s_add_u32 s72, s80, s82
    buffer_load_dwordx4 v[92:95], v0, s[60:63], s72 offen offset:0 sc1
    s_add_u32 s72, s80, s82
    buffer_load_dwordx4 v[132:135], v0, s[60:63], s72 offen offset:1024 sc1
    s_add_u32 s72, s81, s83
    buffer_load_dwordx4 v[204:207], v0, s[60:63], s72 offen offset:0 sc1
    s_add_u32 s98, s98, 1
    s_cmp_gt_u32 s98, 1048576
    s_cbranch_scc1 L_end
    s_waitcnt vmcnt(0)
    v_max_u32 v3, v104, v216
    v_cmp_eq_u32 vcc, -1, v3
    s_cbranch_vccnz L_bc_51r
    s_branch L_bc_51
L_bc_52r:
    s_add_u32 s29, s29, 1
    s_add_u32 s72, s80, 36864
    buffer_load_dwordx4 v[108:111], v0, s[60:63], s72 offen offset:0 sc1
    s_add_u32 s72, s81, 36864
    buffer_load_dwordx4 v[220:223], v0, s[60:63], s72 offen offset:0 sc1
    s_add_u32 s72, s80, 36864
    buffer_load_dwordx4 v[112:115], v0, s[60:63], s72 offen offset:1024 sc1
    s_add_u32 s72, s81, 36864
    buffer_load_dwordx4 v[224:227], v0, s[60:63], s72 offen offset:1024 sc1
    s_add_u32 s72, s80, 36864
    buffer_load_dwordx4 v[116:119], v0, s[60:63], s72 offen offset:2048 sc1
    s_add_u32 s72, s81, 36864
    buffer_load_dwordx4 v[228:231], v0, s[60:63], s72 offen offset:2048 sc1
    s_add_u32 s72, s80, 36864
    buffer_load_dwordx4 v[120:123], v0, s[60:63], s72 offen offset:3072 sc1
    s_add_u32 s72, s81, 36864
    buffer_load_dwordx4 v[232:235], v0, s[60:63], s72 offen offset:3072 sc1
    s_add_u32 s72, s80, s83
    buffer_load_dwordx4 v[88:91], v0, s[60:63], s72 offen offset:0 sc1
    s_add_u32 s72, s80, s83
    buffer_load_dwordx4 v[252:255], v0, s[60:63], s72 offen offset:1024 sc1
    s_add_u32 s72, s80, s83
    buffer_load_dwordx4 v[200:203], v0, s[60:63], s72 offen offset:2048 sc1
    s_add_u32 s72, s80, s83
    buffer_load_dwordx4 v[128:131], v0, s[60:63], s72 offen offset:3072 sc1
    s_add_u32 s72, s80, s82
    buffer_load_dwordx4 v[92:95], v0, s[60:63], s72 offen offset:0 sc1
    s_add_u32 s72, s80, s82
    buffer_load_dwordx4 v[132:135], v0, s[60:63], s72 offen offset:1024 sc1
    s_add_u32 s72, s81, s83
    buffer_load_dwordx4 v[204:207], v0, s[60:63], s72 offen offset:0 sc1
    s_add_u32 s72, s81, s83
    buffer_load_dwordx4 v[136:139], v0, s[60:63], s72 offen offset:1024 sc1
    s_add_u32 s72, s81, s83
    buffer_load_dwordx4 v[96:99], v0, s[60:63], s72 offen offset:2048 sc1
    s_add_u32 s72, s81, s83
    buffer_load_dwordx4 v[140:143], v0, s[60:63], s72 offen offset:3072 sc1
    s_add_u32 s72, s81, s82
    buffer_load_dwordx4 v[208:211], v0, s[60:63], s72 offen offset:0 sc1
    s_add_u32 s98, s98, 1
    s_cmp_gt_u32 s98, 1048576
    s_cbranch_scc1 L_end
    s_waitcnt vmcnt(0)
    v_max_u32 v3, v108, v220
    v_cmp_eq_u32 vcc, -1, v3
    s_cbranch_vccnz L_bc_52r
    s_branch L_bc_52
L_bc_53r:
    s_add_u32 s29, s29, 1
    s_add_u32 s72, s80, 36864
    buffer_load_dwordx4 v[112:115], v0, s[60:63], s72 offen offset:1024 sc1
    s_add_u32 s72, s81, 36864
    buffer_load_dwordx4 v[224:227], v0, s[60:63], s72 offen offset:1024 sc1
    s_add_u32 s72, s80, 36864
    buffer_load_dwordx4 v[116:119], v0, s[60:63], s72 offen offset:2048 sc1
    s_add_u32 s72, s81, 36864
    buffer_load_dwordx4 v[228:231], v0, s[60:63], s72 offen offset:2048 sc1
    s_add_u32 s72, s80, 36864
    buffer_load_dwordx4 v[120:123], v0, s[60:63], s72 offen offset:3072 sc1
    s_add_u32 s72, s81, 36864
    buffer_load_dwordx4 v[232:235], v0, s[60:63], s72 offen offset:3072 sc1
    s_add_u32 s72, s80, s83
    buffer_load_dwordx4 v[88:91], v0, s[60:63], s72 offen offset:0 sc1
    s_add_u32 s72, s80, s83
    buffer_load_dwordx4 v[252:255], v0, s[60:63], s72 offen offset:1024 sc1
    s_add_u32 s72, s80, s83
    buffer_load_dwordx4 v[200:203], v0, s[60:63], s72 offen offset:2048 sc1
    s_add_u32 s72, s80, s83
    buffer_load_dwordx4 v[128:131], v0, s[60:63], s72 offen offset:3072 sc1
    s_add_u32 s72, s80, s82
    buffer_load_dwordx4 v[92:95], v0, s[60:63], s72 offen offset:0 sc1
    s_add_u32 s72, s80, s82
    buffer_load_dwordx4 v[132:135], v0, s[60:63], s72 offen offset:1024 sc1
    s_add_u32 s72, s81, s83
    buffer_load_dwordx4 v[204:207], v0, s[60:63], s72 offen offset:0 sc1
    s_add_u32 s72, s81, s83
    buffer_load_dwordx4 v[136:139], v0, s[60:63], s72 offen offset:1024 sc1
    s_add_u32 s72, s81, s83
    buffer_load_dwordx4 v[96:99], v0, s[60:63], s72 offen offset:2048 sc1
    s_add_u32 s72, s81, s83
    buffer_load_dwordx4 v[140:143], v0, s[60:63], s72 offen offset:3072 sc1
    s_add_u32 s72, s81, s82
    buffer_load_dwordx4 v[208:211], v0, s[60:63], s72 offen offset:0 sc1
    s_add_u32 s72, s81, s82
    buffer_load_dwordx4 v[144:147], v0, s[60:63], s72 offen offset:1024 sc1
    s_add_u32 s98, s98, 1
    s_cmp_gt_u32 s98, 1048576
    s_cbranch_scc1 L_end
    s_waitcnt vmcnt(0)
    v_max_u32 v3, v112, v224
    v_cmp_eq_u32 vcc, -1, v3
    s_cbranch_vccnz L_bc_53r
    s_branch L_bc_53
L_bc_54r:
    s_add_u32 s29, s29, 1
    s_add_u32 s72, s80, 36864
    buffer_load_dwordx4 v[116:119], v0, s[60:63], s72 offen offset:2048 sc1
    s_add_u32 s72, s81, 36864
    buffer_load_dwordx4 v[228:231], v0, s[60:63], s72 offen offset:2048 sc1
    s_add_u32 s72, s80, 36864
    buffer_load_dwordx4 v[120:123], v0, s[60:63], s72 offen offset:3072 sc1
    s_add_u32 s72, s81, 36864
    buffer_load_dwordx4 v[232:235], v0, s[60:63], s72 offen offset:3072 sc1
    s_add_u32 s72, s80, s83
    buffer_load_dwordx4 v[88:91], v0, s[60:63], s72 offen offset:0 sc1
    s_add_u32 s72, s80, s83
    buffer_load_dwordx4 v[252:255], v0, s[60:63], s72 offen offset:1024 sc1
    s_add_u32 s72, s80, s83
    buffer_load_dwordx4 v[200:203], v0, s[60:63], s72 offen offset:2048 sc1
    s_add_u32 s72, s80, s83
    buffer_load_dwordx4 v[128:131], v0, s[60:63], s72 offen offset:3072 sc1
    s_add_u32 s72, s80, s82
    buffer_load_dwordx4 v[92:95], v0, s[60:63], s72 offen offset:0 sc1
    s_add_u32 s72, s80, s82
    buffer_load_dwordx4 v[132:135], v0, s[60:63], s72 offen offset:1024 sc1
    s_add_u32 s72, s81, s83
    buffer_load_dwordx4 v[204:207], v0, s[60:63], s72 offen offset:0 sc1
    s_add_u32 s72, s81, s83
    buffer_load_dwordx4 v[136:139], v0, s[60:63], s72 offen offset:1024 sc1
    s_add_u32 s72, s81, s83
    buffer_load_dwordx4 v[96:99], v0, s[60:63], s72 offen offset:2048 sc1
    s_add_u32 s72, s81, s83
    buffer_load_dwordx4 v[140:143], v0, s[60:63], s72 offen offset:3072 sc1
    s_add_u32 s72, s81, s82
    buffer_load_dwordx4 v[208:211], v0, s[60:63], s72 offen offset:0 sc1
    s_add_u32 s72, s81, s82
    buffer_load_dwordx4 v[144:147], v0, s[60:63], s72 offen offset:1024 sc1
    s_add_u32 s98, s98, 1
    s_cmp_gt_u32 s98, 1048576
    s_cbranch_scc1 L_end
    s_waitcnt vmcnt(0)
    v_max_u32 v3, v116, v228
    v_cmp_eq_u32 vcc, -1, v3
    s_cbranch_vccnz L_bc_54r
    s_branch L_bc_54
L_bc_55r:
    s_add_u32 s29, s29, 1
    s_add_u32 s72, s80, 36864
    buffer_load_dwordx4 v[120:123], v0, s[60:63], s72 offen offset:3072 sc1
    s_add_u32 s72, s81, 36864
    buffer_load_dwordx4 v[232:235], v0, s[60:63], s72 offen offset:3072 sc1
    s_add_u32 s72, s80, s83
    buffer_load_dwordx4 v[88:91], v0, s[60:63], s72 offen offset:0 sc1
    s_add_u32 s72, s80, s83
    buffer_load_dwordx4 v[252:255], v0, s[60:63], s72 offen offset:1024 sc1
    s_add_u32 s72, s80, s83
    buffer_load_dwordx4 v[200:203], v0, s[60:63], s72 offen offset:2048 sc1
    s_add_u32 s72, s80, s83
    buffer_load_dwordx4 v[128:131], v0, s[60:63], s72 offen offset:3072 sc1
    s_add_u32 s72, s80, s82
    buffer_load_dwordx4 v[92:95], v0, s[60:63], s72 offen offset:0 sc1
    s_add_u32 s72, s80, s82
    buffer_load_dwordx4 v[132:135], v0, s[60:63], s72 offen offset:1024 sc1
    s_add_u32 s72, s81, s83
    buffer_load_dwordx4 v[204:207], v0, s[60:63], s72 offen offset:0 sc1
    s_add_u32 s72, s81, s83
    buffer_load_dwordx4 v[136:139], v0, s[60:63], s72 offen offset:1024 sc1
    s_add_u32 s72, s81, s83
    buffer_load_dwordx4 v[96:99], v0, s[60:63], s72 offen offset:2048 sc1
    s_add_u32 s72, s81, s83
    buffer_load_dwordx4 v[140:143], v0, s[60:63], s72 offen offset:3072 sc1
    s_add_u32 s72, s81, s82
    buffer_load_dwordx4 v[208:211], v0, s[60:63], s72 offen offset:0 sc1
    s_add_u32 s72, s81, s82
    buffer_load_dwordx4 v[144:147], v0, s[60:63], s72 offen offset:1024 sc1
    s_add_u32 s98, s98, 1
    s_cmp_gt_u32 s98, 1048576
    s_cbranch_scc1 L_end
    s_waitcnt vmcnt(0)
    v_max_u32 v3, v120, v232
    v_cmp_eq_u32 vcc, -1, v3
    s_cbranch_vccnz L_bc_55r
    s_branch L_bc_55
L_bc_56r:
    s_add_u32 s29, s29, 1
    s_add_u32 s72, s80, s83
    buffer_load_dwordx4 v[88:91], v0, s[60:63], s72 offen offset:0 sc1
    s_add_u32 s72, s80, s83
    buffer_load_dwordx4 v[252:255], v0, s[60:63], s72 offen offset:1024 sc1
    s_add_u32 s72, s80, s83
    buffer_load_dwordx4 v[200:203], v0, s[60:63], s72 offen offset:2048 sc1
    s_add_u32 s72, s80, s83
    buffer_load_dwordx4 v[128:131], v0, s[60:63], s72 offen offset:3072 sc1
    s_add_u32 s72, s80, s82
    buffer_load_dwordx4 v[92:95], v0, s[60:63], s72 offen offset:0 sc1
    s_add_u32 s72, s80, s82
    buffer_load_dwordx4 v[132:135], v0, s[60:63], s72 offen offset:1024 sc1
    s_add_u32 s72, s81, s83
    buffer_load_dwordx4 v[204:207], v0, s[60:63], s72 offen offset:0 sc1
    s_add_u32 s72, s81, s83
    buffer_load_dwordx4 v[136:139], v0, s[60:63], s72 offen offset:1024 sc1
    s_add_u32 s72, s81, s83
    buffer_load_dwordx4 v[96:99], v0, s[60:63], s72 offen offset:2048 sc1
    s_add_u32 s72, s81, s83
    buffer_load_dwordx4 v[140:143], v0, s[60:63], s72 offen offset:3072 sc1
    s_add_u32 s72, s81, s82
    buffer_load_dwordx4 v[208:211], v0, s[60:63], s72 offen offset:0 sc1
    s_add_u32 s72, s81, s82
    buffer_load_dwordx4 v[144:147], v0, s[60:63], s72 offen offset:1024 sc1
    s_add_u32 s98, s98, 1
    s_cmp_gt_u32 s98, 1048576
    s_cbranch_scc1 L_end
    s_waitcnt vmcnt(0)
    v_max_u32 v3, v88, v252
    v_max3_u32 v3, v3, v200, v128
    v_max3_u32 v3, v3, v92, v132
    v_cmp_eq_u32 vcc, -1, v3
    s_cbranch_vccnz L_bc_56r
    s_branch L_bc_56
L_bc_57r:
    s_add_u32 s29, s29, 1
    s_add_u32 s72, s81, s83
    buffer_load_dwordx4 v[204:207], v0, s[60:63], s72 offen offset:0 sc1
    s_add_u32 s72, s81, s83
    buffer_load_dwordx4 v[136:139], v0, s[60:63], s72 offen offset:1024 sc1
    s_add_u32 s72, s81, s83
    buffer_load_dwordx4 v[96:99], v0, s[60:63], s72 offen offset:2048 sc1
    s_add_u32 s72, s81, s83
    buffer_load_dwordx4 v[140:143], v0, s[60:63], s72 offen offset:3072 sc1
    s_add_u32 s72, s81, s82
    buffer_load_dwordx4 v[208:211], v0, s[60:63], s72 offen offset:0 sc1
    s_add_u32 s72, s81, s82
    buffer_load_dwordx4 v[144:147], v0, s[60:63], s72 offen offset:1024 sc1
    s_add_u32 s98, s98, 1
    s_cmp_gt_u32 s98, 1048576
    s_cbranch_scc1 L_end
    s_waitcnt vmcnt(0)
    v_max_u32 v3, v204, v136
    v_max3_u32 v3, v3, v96, v140
    v_max3_u32 v3, v3, v208, v144
    v_cmp_eq_u32 vcc, -1, v3
    s_cbranch_vccnz L_bc_57r
    s_branch L_bc_57
L_f2_w1:
    s_mov_b32 s98, 0
L_lw_58:
    v_mov_b32 v3, 132116
    ds_read_b32 v3, v3
    s_add_u32 s98, s98, 1
    s_cmp_gt_u32 s98, 1048576
    s_cbranch_scc1 L_end
    s_waitcnt lgkmcnt(0)
    v_readfirstlane_b32 s79, v3
    s_nop 0
    s_cmp_ge_u32 s79, 4
    s_cbranch_scc0 L_lw_58
    s_branch L_f2_w1b
L_ls_8s:
    buffer_store_dwordx4 v[8:11], v0, s[60:63], s75 offen sc1
    buffer_store_dwordx4 v[12:15], v0, s[60:63], s75 offen offset:1024 sc1
    s_branch L_ls_8b
L_ls_9s:
    buffer_store_dwordx4 v[8:11], v0, s[60:63], s75 offen sc1
    buffer_store_dwordx4 v[12:15], v0, s[60:63], s75 offen offset:1024 sc1
    s_branch L_ls_9b
L_ls_10s:
    buffer_store_dwordx4 v[8:11], v0, s[60:63], s75 offen sc1
    buffer_store_dwordx4 v[12:15], v0, s[60:63], s75 offen offset:1024 sc1
    s_branch L_ls_10b
L_ls_11s:
    buffer_store_dwordx4 v[8:11], v0, s[60:63], s75 offen sc1
    buffer_store_dwordx4 v[12:15], v0, s[60:63], s75 offen offset:1024 sc1
    s_branch L_ls_11b
L_ls_12s:
    buffer_store_dwordx4 v[8:11], v0, s[60:63], s75 offen sc1
    buffer_store_dwordx4 v[12:15], v0, s[60:63], s75 offen offset:1024 sc1
    s_branch L_ls_12b
L_ls_21s:
    buffer_store_dwordx4 v[48:51], v30, s[60:63], s74 offen sc1
    buffer_store_dwordx4 v[52:55], v30, s[60:63], s74 offen offset:128 sc1
    s_branch L_ls_21b
L_ls_22s:
    buffer_store_dword v26, v0, s[60:63], s72 offen sc1
    s_branch L_ls_22b
L_ls_27s:
    buffer_store_dword v26, v0, s[60:63], s72 offen sc1
    s_branch L_ls_27b
L_ls_34s:
    buffer_store_dwordx4 v[56:59], v27, s[60:63], s74 offen sc1
    buffer_store_dwordx4 v[60:63], v27, s[60:63], s74 offen offset:2048 sc1
    s_branch L_ls_34b
L_ls_36s:
    buffer_store_dwordx4 v[64:67], v3, s[56:59], s72 offen offset:0 sc1
    buffer_store_dwordx4 v[68:71], v3, s[56:59], s72 offen offset:64 sc1
    s_branch L_ls_36b
L_ls_37s:
    buffer_store_dword v26, v0, s[60:63], s72 offen sc1
    s_branch L_ls_37b
L_s_safe:
    s_mov_b32 s101, 1
    s_waitcnt lgkmcnt(0)
    s_barrier
    s_barrier
    s_branch L_s_loop0
L_a_safe:
    s_mov_b32 s101, 1
    s_waitcnt vmcnt(0)
    v_lshrrev_b32 v9, 2, v0
    s_lshl_b32 s72, s64, 8
    s_add_u32 s72, s72, 162816
    v_add_u32 v9, s72, v9
    v_mov_b32 v8, 0xff800000
    ds_write_b32 v9, v8
    s_waitcnt lgkmcnt(0)
    s_barrier
    v_add_u32 v2, 133120, v0
    v_bfe_u32 v9, v0, 2, 7
    v_add_u32 v9, 162816, v9
    s_mov_b32 s99, 0
L_safe1:
    ds_read_b128 v[4:7], v2
    v_mov_b32 v8, 0xff800000
    s_waitcnt lgkmcnt(0)
    v_mfma_f32_32x32x16_bf16 v[32:47], v[64:67], v[4:7], 0
    s_nop 11
    v_max3_f32 v8, v8, v32, v33
    v_max3_f32 v8, v8, v34, v35
    v_max3_f32 v8, v8, v36, v37
    v_max3_f32 v8, v8, v38, v39
    v_max3_f32 v8, v8, v40, v41
    v_max3_f32 v8, v8, v42, v43
    v_max3_f32 v8, v8, v44, v45
    v_max3_f32 v8, v8, v46, v47
    v_mfma_f32_32x32x16_bf16 v[32:47], v[68:71], v[4:7], 0
    s_nop 11
    v_max3_f32 v8, v8, v32, v33
    v_max3_f32 v8, v8, v34, v35
    v_max3_f32 v8, v8, v36, v37
    v_max3_f32 v8, v8, v38, v39
    v_max3_f32 v8, v8, v40, v41
    v_max3_f32 v8, v8, v42, v43
    v_max3_f32 v8, v8, v44, v45
    v_max3_f32 v8, v8, v46, v47
    v_mfma_f32_32x32x16_bf16 v[32:47], v[72:75], v[4:7], 0
    s_nop 11
    v_max3_f32 v8, v8, v32, v33
    v_max3_f32 v8, v8, v34, v35
    v_max3_f32 v8, v8, v36, v37
    v_max3_f32 v8, v8, v38, v39
    v_max3_f32 v8, v8, v40, v41
    v_max3_f32 v8, v8, v42, v43
    v_max3_f32 v8, v8, v44, v45
    v_max3_f32 v8, v8, v46, v47
    v_mfma_f32_32x32x16_bf16 v[32:47], v[76:79], v[4:7], 0
    s_nop 11
    v_max3_f32 v8, v8, v32, v33
    v_max3_f32 v8, v8, v34, v35
    v_max3_f32 v8, v8, v36, v37
    v_max3_f32 v8, v8, v38, v39
    v_max3_f32 v8, v8, v40, v41
    v_max3_f32 v8, v8, v42, v43
    v_max3_f32 v8, v8, v44, v45
    v_max3_f32 v8, v8, v46, v47
    v_mfma_f32_32x32x16_bf16 v[32:47], v[80:83], v[4:7], 0
    s_nop 11
    v_max3_f32 v8, v8, v32, v33
    v_max3_f32 v8, v8, v34, v35
    v_max3_f32 v8, v8, v36, v37
    v_max3_f32 v8, v8, v38, v39
    v_max3_f32 v8, v8, v40, v41
    v_max3_f32 v8, v8, v42, v43
    v_max3_f32 v8, v8, v44, v45
    v_max3_f32 v8, v8, v46, v47
    v_mfma_f32_32x32x16_bf16 v[32:47], v[84:87], v[4:7], 0
    s_nop 11
    v_max3_f32 v8, v8, v32, v33
    v_max3_f32 v8, v8, v34, v35
    v_max3_f32 v8, v8, v36, v37
    v_max3_f32 v8, v8, v38, v39
    v_max3_f32 v8, v8, v40, v41
    v_max3_f32 v8, v8, v42, v43
    v_max3_f32 v8, v8, v44, v45
    v_max3_f32 v8, v8, v46, v47
    v_mfma_f32_32x32x16_bf16 v[32:47], v[88:91], v[4:7], 0
    s_nop 11
    v_max3_f32 v8, v8, v32, v33
    v_max3_f32 v8, v8, v34, v35
    v_max3_f32 v8, v8, v36, v37
    v_max3_f32 v8, v8, v38, v39
    v_max3_f32 v8, v8, v40, v41
    v_max3_f32 v8, v8, v42, v43
    v_max3_f32 v8, v8, v44, v45
    v_max3_f32 v8, v8, v46, v47
    v_mfma_f32_32x32x16_bf16 v[32:47], v[92:95], v[4:7], 0
    s_nop 11
    v_max3_f32 v8, v8, v32, v33
    v_max3_f32 v8, v8, v34, v35
    v_max3_f32 v8, v8, v36, v37
    v_max3_f32 v8, v8, v38, v39
    v_max3_f32 v8, v8, v40, v41
    v_max3_f32 v8, v8, v42, v43
    v_max3_f32 v8, v8, v44, v45
    v_max3_f32 v8, v8, v46, v47
    v_mfma_f32_32x32x16_bf16 v[32:47], v[96:99], v[4:7], 0
    s_nop 11
    v_max3_f32 v8, v8, v32, v33
    v_max3_f32 v8, v8, v34, v35
    v_max3_f32 v8, v8, v36, v37
    v_max3_f32 v8, v8, v38, v39
    v_max3_f32 v8, v8, v40, v41
    v_max3_f32 v8, v8, v42, v43
    v_max3_f32 v8, v8, v44, v45
    v_max3_f32 v8, v8, v46, v47
    v_mfma_f32_32x32x16_bf16 v[32:47], v[100:103], v[4:7], 0
    s_nop 11
    v_max3_f32 v8, v8, v32, v33
    v_max3_f32 v8, v8, v34, v35
    v_max3_f32 v8, v8, v36, v37
    v_max3_f32 v8, v8, v38, v39
    v_max3_f32 v8, v8, v40, v41
    v_max3_f32 v8, v8, v42, v43
    v_max3_f32 v8, v8, v44, v45
    v_max3_f32 v8, v8, v46, v47
    v_mfma_f32_32x32x16_bf16 v[32:47], v[104:107], v[4:7], 0
    s_nop 11
    v_max3_f32 v8, v8, v32, v33
    v_max3_f32 v8, v8, v34, v35
    v_max3_f32 v8, v8, v36, v37
    v_max3_f32 v8, v8, v38, v39
    v_max3_f32 v8, v8, v40, v41
    v_max3_f32 v8, v8, v42, v43
    v_max3_f32 v8, v8, v44, v45
    v_max3_f32 v8, v8, v46, v47
    v_mfma_f32_32x32x16_bf16 v[32:47], v[108:111], v[4:7], 0
    s_nop 11
    v_max3_f32 v8, v8, v32, v33
    v_max3_f32 v8, v8, v34, v35
    v_max3_f32 v8, v8, v36, v37
    v_max3_f32 v8, v8, v38, v39
    v_max3_f32 v8, v8, v40, v41
    v_max3_f32 v8, v8, v42, v43
    v_max3_f32 v8, v8, v44, v45
    v_max3_f32 v8, v8, v46, v47
    v_mfma_f32_32x32x16_bf16 v[32:47], v[112:115], v[4:7], 0
    s_nop 11
    v_max3_f32 v8, v8, v32, v33
    v_max3_f32 v8, v8, v34, v35
    v_max3_f32 v8, v8, v36, v37
    v_max3_f32 v8, v8, v38, v39
    v_max3_f32 v8, v8, v40, v41
    v_max3_f32 v8, v8, v42, v43
    v_max3_f32 v8, v8, v44, v45
    v_max3_f32 v8, v8, v46, v47
    v_mfma_f32_32x32x16_bf16 v[32:47], v[116:119], v[4:7], 0
    s_nop 11
    v_max3_f32 v8, v8, v32, v33
    v_max3_f32 v8, v8, v34, v35
    v_max3_f32 v8, v8, v36, v37
    v_max3_f32 v8, v8, v38, v39
    v_max3_f32 v8, v8, v40, v41
    v_max3_f32 v8, v8, v42, v43
    v_max3_f32 v8, v8, v44, v45
    v_max3_f32 v8, v8, v46, v47
    v_mfma_f32_32x32x16_bf16 v[32:47], v[120:123], v[4:7], 0
    s_nop 11
    v_max3_f32 v8, v8, v32, v33
    v_max3_f32 v8, v8, v34, v35
    v_max3_f32 v8, v8, v36, v37
    v_max3_f32 v8, v8, v38, v39
    v_max3_f32 v8, v8, v40, v41
    v_max3_f32 v8, v8, v42, v43
    v_max3_f32 v8, v8, v44, v45
    v_max3_f32 v8, v8, v46, v47
    v_mfma_f32_32x32x16_bf16 v[32:47], v[124:127], v[4:7], 0
    s_nop 11
    v_max3_f32 v8, v8, v32, v33
    v_max3_f32 v8, v8, v34, v35
    v_max3_f32 v8, v8, v36, v37
    v_max3_f32 v8, v8, v38, v39
    v_max3_f32 v8, v8, v40, v41
    v_max3_f32 v8, v8, v42, v43
    v_max3_f32 v8, v8, v44, v45
    v_max3_f32 v8, v8, v46, v47
    ds_max_f32 v9, v8
    v_add_u32 v9, 128, v9
    v_add_u32 v2, 1024, v2
    s_add_u32 s99, s99, 1
    s_cmp_lt_u32 s99, 8
    s_cbranch_scc1 L_safe1
    s_waitcnt lgkmcnt(0)
    s_barrier
    v_add_u32 v2, 133120, v0
    s_mov_b32 s99, 0
L_safe2:
    s_lshl_b32 s72, s99, 7
    s_add_u32 s72, s72, 162816
    v_bfe_u32 v9, v0, 2, 7
    v_add_u32 v9, s72, v9
    ds_read_b128 v[4:7], v2
    ds_read_b32 v8, v9
    s_waitcnt lgkmcnt(0)
    v_sub_f32 v48, 0, v8
    v_sub_f32 v49, 0, v8
    v_sub_f32 v50, 0, v8
    v_sub_f32 v51, 0, v8
    v_sub_f32 v52, 0, v8
    v_sub_f32 v53, 0, v8
    v_sub_f32 v54, 0, v8
    v_sub_f32 v55, 0, v8
    v_sub_f32 v56, 0, v8
    v_sub_f32 v57, 0, v8
    v_sub_f32 v58, 0, v8
    v_sub_f32 v59, 0, v8
    v_sub_f32 v60, 0, v8
    v_sub_f32 v61, 0, v8
    v_sub_f32 v62, 0, v8
    v_sub_f32 v63, 0, v8
    s_nop 1
    v_mfma_f32_32x32x16_bf16 v[32:47], v[64:67], v[4:7], v[48:63]
    s_nop 11
    v_exp_f32 v32, v32
    v_exp_f32 v33, v33
    v_exp_f32 v34, v34
    v_exp_f32 v35, v35
    v_exp_f32 v36, v36
    v_exp_f32 v37, v37
    v_exp_f32 v38, v38
    v_exp_f32 v39, v39
    v_exp_f32 v40, v40
    v_exp_f32 v41, v41
    v_exp_f32 v42, v42
    v_exp_f32 v43, v43
    v_exp_f32 v44, v44
    v_exp_f32 v45, v45
    v_exp_f32 v46, v46
    v_exp_f32 v47, v47
    v_cvt_pk_bf16_f32 v8, v32, v33
    v_cvt_pk_bf16_f32 v9, v34, v35
    v_cvt_pk_bf16_f32 v10, v36, v37
    v_cvt_pk_bf16_f32 v11, v38, v39
    v_cvt_pk_bf16_f32 v12, v40, v41
    v_cvt_pk_bf16_f32 v13, v42, v43
    v_cvt_pk_bf16_f32 v14, v44, v45
    v_cvt_pk_bf16_f32 v15, v46, v47
    v_mfma_f32_32x32x16_bf16 v[16:31], v[128:131], v[8:11], 0
    s_nop 0
    v_mfma_f32_32x32x16_bf16 v[16:31], v[132:135], v[12:15], v[16:31]
    v_mfma_f32_32x32x16_bf16 v[32:47], v[68:71], v[4:7], v[48:63]
    s_nop 11
    v_exp_f32 v32, v32
    v_exp_f32 v33, v33
    v_exp_f32 v34, v34
    v_exp_f32 v35, v35
    v_exp_f32 v36, v36
    v_exp_f32 v37, v37
    v_exp_f32 v38, v38
    v_exp_f32 v39, v39
    v_exp_f32 v40, v40
    v_exp_f32 v41, v41
    v_exp_f32 v42, v42
    v_exp_f32 v43, v43
    v_exp_f32 v44, v44
    v_exp_f32 v45, v45
    v_exp_f32 v46, v46
    v_exp_f32 v47, v47
    v_cvt_pk_bf16_f32 v8, v32, v33
    v_cvt_pk_bf16_f32 v9, v34, v35
    v_cvt_pk_bf16_f32 v10, v36, v37
    v_cvt_pk_bf16_f32 v11, v38, v39
    v_cvt_pk_bf16_f32 v12, v40, v41
    v_cvt_pk_bf16_f32 v13, v42, v43
    v_cvt_pk_bf16_f32 v14, v44, v45
    v_cvt_pk_bf16_f32 v15, v46, v47
    v_mfma_f32_32x32x16_bf16 v[16:31], v[136:139], v[8:11], v[16:31]
    s_nop 0
    v_mfma_f32_32x32x16_bf16 v[16:31], v[140:143], v[12:15], v[16:31]
    v_mfma_f32_32x32x16_bf16 v[32:47], v[72:75], v[4:7], v[48:63]
    s_nop 11
    v_exp_f32 v32, v32
    v_exp_f32 v33, v33
    v_exp_f32 v34, v34
    v_exp_f32 v35, v35
    v_exp_f32 v36, v36
    v_exp_f32 v37, v37
    v_exp_f32 v38, v38
    v_exp_f32 v39, v39
    v_exp_f32 v40, v40
    v_exp_f32 v41, v41
    v_exp_f32 v42, v42
    v_exp_f32 v43, v43
    v_exp_f32 v44, v44
    v_exp_f32 v45, v45
    v_exp_f32 v46, v46
    v_exp_f32 v47, v47
    v_cvt_pk_bf16_f32 v8, v32, v33
    v_cvt_pk_bf16_f32 v9, v34, v35
    v_cvt_pk_bf16_f32 v10, v36, v37
    v_cvt_pk_bf16_f32 v11, v38, v39
    v_cvt_pk_bf16_f32 v12, v40, v41
    v_cvt_pk_bf16_f32 v13, v42, v43
    v_cvt_pk_bf16_f32 v14, v44, v45
    v_cvt_pk_bf16_f32 v15, v46, v47
    v_mfma_f32_32x32x16_bf16 v[16:31], v[144:147], v[8:11], v[16:31]
    s_nop 0
    v_mfma_f32_32x32x16_bf16 v[16:31], v[148:151], v[12:15], v[16:31]
    v_mfma_f32_32x32x16_bf16 v[32:47], v[76:79], v[4:7], v[48:63]
    s_nop 11
    v_exp_f32 v32, v32
    v_exp_f32 v33, v33
    v_exp_f32 v34, v34
    v_exp_f32 v35, v35
    v_exp_f32 v36, v36
    v_exp_f32 v37, v37
    v_exp_f32 v38, v38
    v_exp_f32 v39, v39
    v_exp_f32 v40, v40
    v_exp_f32 v41, v41
    v_exp_f32 v42, v42
    v_exp_f32 v43, v43
    v_exp_f32 v44, v44
    v_exp_f32 v45, v45
    v_exp_f32 v46, v46
    v_exp_f32 v47, v47
    v_cvt_pk_bf16_f32 v8, v32, v33
    v_cvt_pk_bf16_f32 v9, v34, v35
    v_cvt_pk_bf16_f32 v10, v36, v37
    v_cvt_pk_bf16_f32 v11, v38, v39
    v_cvt_pk_bf16_f32 v12, v40, v41
    v_cvt_pk_bf16_f32 v13, v42, v43
    v_cvt_pk_bf16_f32 v14, v44, v45
    v_cvt_pk_bf16_f32 v15, v46, v47
    v_mfma_f32_32x32x16_bf16 v[16:31], v[152:155], v[8:11], v[16:31]
    s_nop 0
    v_mfma_f32_32x32x16_bf16 v[16:31], v[156:159], v[12:15], v[16:31]
    v_mfma_f32_32x32x16_bf16 v[32:47], v[80:83], v[4:7], v[48:63]
    s_nop 11
    v_exp_f32 v32, v32
    v_exp_f32 v33, v33
    v_exp_f32 v34, v34
    v_exp_f32 v35, v35
    v_exp_f32 v36, v36
    v_exp_f32 v37, v37
    v_exp_f32 v38, v38
    v_exp_f32 v39, v39
    v_exp_f32 v40, v40
    v_exp_f32 v41, v41
    v_exp_f32 v42, v42
    v_exp_f32 v43, v43
    v_exp_f32 v44, v44
    v_exp_f32 v45, v45
    v_exp_f32 v46, v46
    v_exp_f32 v47, v47
    v_cvt_pk_bf16_f32 v8, v32, v33
    v_cvt_pk_bf16_f32 v9, v34, v35
    v_cvt_pk_bf16_f32 v10, v36, v37
    v_cvt_pk_bf16_f32 v11, v38, v39
    v_cvt_pk_bf16_f32 v12, v40, v41
    v_cvt_pk_bf16_f32 v13, v42, v43
    v_cvt_pk_bf16_f32 v14, v44, v45
    v_cvt_pk_bf16_f32 v15, v46, v47
    v_mfma_f32_32x32x16_bf16 v[16:31], v[160:163], v[8:11], v[16:31]
    s_nop 0
    v_mfma_f32_32x32x16_bf16 v[16:31], v[164:167], v[12:15], v[16:31]
    v_mfma_f32_32x32x16_bf16 v[32:47], v[84:87], v[4:7], v[48:63]
    s_nop 11
    v_exp_f32 v32, v32
    v_exp_f32 v33, v33
    v_exp_f32 v34, v34
    v_exp_f32 v35, v35
    v_exp_f32 v36, v36
    v_exp_f32 v37, v37
    v_exp_f32 v38, v38
    v_exp_f32 v39, v39
    v_exp_f32 v40, v40
    v_exp_f32 v41, v41
    v_exp_f32 v42, v42
    v_exp_f32 v43, v43
    v_exp_f32 v44, v44
    v_exp_f32 v45, v45
    v_exp_f32 v46, v46
    v_exp_f32 v47, v47
    v_cvt_pk_bf16_f32 v8, v32, v33
    v_cvt_pk_bf16_f32 v9, v34, v35
    v_cvt_pk_bf16_f32 v10, v36, v37
    v_cvt_pk_bf16_f32 v11, v38, v39
    v_cvt_pk_bf16_f32 v12, v40, v41
    v_cvt_pk_bf16_f32 v13, v42, v43
    v_cvt_pk_bf16_f32 v14, v44, v45
    v_cvt_pk_bf16_f32 v15, v46, v47
    v_mfma_f32_32x32x16_bf16 v[16:31], v[168:171], v[8:11], v[16:31]
    s_nop 0
    v_mfma_f32_32x32x16_bf16 v[16:31], v[172:175], v[12:15], v[16:31]
    v_mfma_f32_32x32x16_bf16 v[32:47], v[88:91], v[4:7], v[48:63]
    s_nop 11
    v_exp_f32 v32, v32
    v_exp_f32 v33, v33
    v_exp_f32 v34, v34
    v_exp_f32 v35, v35
    v_exp_f32 v36, v36
    v_exp_f32 v37, v37
    v_exp_f32 v38, v38
    v_exp_f32 v39, v39
    v_exp_f32 v40, v40
    v_exp_f32 v41, v41
    v_exp_f32 v42, v42
    v_exp_f32 v43, v43
    v_exp_f32 v44, v44
    v_exp_f32 v45, v45
    v_exp_f32 v46, v46
    v_exp_f32 v47, v47
    v_cvt_pk_bf16_f32 v8, v32, v33
    v_cvt_pk_bf16_f32 v9, v34, v35
    v_cvt_pk_bf16_f32 v10, v36, v37
    v_cvt_pk_bf16_f32 v11, v38, v39
    v_cvt_pk_bf16_f32 v12, v40, v41
    v_cvt_pk_bf16_f32 v13, v42, v43
    v_cvt_pk_bf16_f32 v14, v44, v45
    v_cvt_pk_bf16_f32 v15, v46, v47
    v_mfma_f32_32x32x16_bf16 v[16:31], v[176:179], v[8:11], v[16:31]
    s_nop 0
    v_mfma_f32_32x32x16_bf16 v[16:31], v[180:183], v[12:15], v[16:31]
    v_mfma_f32_32x32x16_bf16 v[32:47], v[92:95], v[4:7], v[48:63]
    s_nop 11
    v_exp_f32 v32, v32
    v_exp_f32 v33, v33
    v_exp_f32 v34, v34
    v_exp_f32 v35, v35
    v_exp_f32 v36, v36
    v_exp_f32 v37, v37
    v_exp_f32 v38, v38
    v_exp_f32 v39, v39
    v_exp_f32 v40, v40
    v_exp_f32 v41, v41
    v_exp_f32 v42, v42
    v_exp_f32 v43, v43
    v_exp_f32 v44, v44
    v_exp_f32 v45, v45
    v_exp_f32 v46, v46
    v_exp_f32 v47, v47
    v_cvt_pk_bf16_f32 v8, v32, v33
    v_cvt_pk_bf16_f32 v9, v34, v35
    v_cvt_pk_bf16_f32 v10, v36, v37
    v_cvt_pk_bf16_f32 v11, v38, v39
    v_cvt_pk_bf16_f32 v12, v40, v41
    v_cvt_pk_bf16_f32 v13, v42, v43
    v_cvt_pk_bf16_f32 v14, v44, v45
    v_cvt_pk_bf16_f32 v15, v46, v47
    v_mfma_f32_32x32x16_bf16 v[16:31], v[184:187], v[8:11], v[16:31]
    s_nop 0
    v_mfma_f32_32x32x16_bf16 v[16:31], v[188:191], v[12:15], v[16:31]
    v_mfma_f32_32x32x16_bf16 v[32:47], v[96:99], v[4:7], v[48:63]
    s_nop 11
    v_exp_f32 v32, v32
    v_exp_f32 v33, v33
    v_exp_f32 v34, v34
    v_exp_f32 v35, v35
    v_exp_f32 v36, v36
    v_exp_f32 v37, v37
    v_exp_f32 v38, v38
    v_exp_f32 v39, v39
    v_exp_f32 v40, v40
    v_exp_f32 v41, v41
    v_exp_f32 v42, v42
    v_exp_f32 v43, v43
    v_exp_f32 v44, v44
    v_exp_f32 v45, v45
    v_exp_f32 v46, v46
    v_exp_f32 v47, v47
    v_cvt_pk_bf16_f32 v8, v32, v33
    v_cvt_pk_bf16_f32 v9, v34, v35
    v_cvt_pk_bf16_f32 v10, v36, v37
    v_cvt_pk_bf16_f32 v11, v38, v39
    v_cvt_pk_bf16_f32 v12, v40, v41
    v_cvt_pk_bf16_f32 v13, v42, v43
    v_cvt_pk_bf16_f32 v14, v44, v45
    v_cvt_pk_bf16_f32 v15, v46, v47
    v_mfma_f32_32x32x16_bf16 v[16:31], v[192:195], v[8:11], v[16:31]
    s_nop 0
    v_mfma_f32_32x32x16_bf16 v[16:31], v[196:199], v[12:15], v[16:31]
    v_mfma_f32_32x32x16_bf16 v[32:47], v[100:103], v[4:7], v[48:63]
    s_nop 11
    v_exp_f32 v32, v32
    v_exp_f32 v33, v33
    v_exp_f32 v34, v34
    v_exp_f32 v35, v35
    v_exp_f32 v36, v36
    v_exp_f32 v37, v37
    v_exp_f32 v38, v38
    v_exp_f32 v39, v39
    v_exp_f32 v40, v40
    v_exp_f32 v41, v41
    v_exp_f32 v42, v42
    v_exp_f32 v43, v43
    v_exp_f32 v44, v44
    v_exp_f32 v45, v45
    v_exp_f32 v46, v46
    v_exp_f32 v47, v47
    v_cvt_pk_bf16_f32 v8, v32, v33
    v_cvt_pk_bf16_f32 v9, v34, v35
    v_cvt_pk_bf16_f32 v10, v36, v37
    v_cvt_pk_bf16_f32 v11, v38, v39
    v_cvt_pk_bf16_f32 v12, v40, v41
    v_cvt_pk_bf16_f32 v13, v42, v43
    v_cvt_pk_bf16_f32 v14, v44, v45
    v_cvt_pk_bf16_f32 v15, v46, v47
    v_mfma_f32_32x32x16_bf16 v[16:31], v[200:203], v[8:11], v[16:31]
    s_nop 0
    v_mfma_f32_32x32x16_bf16 v[16:31], v[204:207], v[12:15], v[16:31]
    v_mfma_f32_32x32x16_bf16 v[32:47], v[104:107], v[4:7], v[48:63]
    s_nop 11
    v_exp_f32 v32, v32
    v_exp_f32 v33, v33
    v_exp_f32 v34, v34
    v_exp_f32 v35, v35
    v_exp_f32 v36, v36
    v_exp_f32 v37, v37
    v_exp_f32 v38, v38
    v_exp_f32 v39, v39
    v_exp_f32 v40, v40
    v_exp_f32 v41, v41
    v_exp_f32 v42, v42
    v_exp_f32 v43, v43
    v_exp_f32 v44, v44
    v_exp_f32 v45, v45
    v_exp_f32 v46, v46
    v_exp_f32 v47, v47
    v_cvt_pk_bf16_f32 v8, v32, v33
    v_cvt_pk_bf16_f32 v9, v34, v35
    v_cvt_pk_bf16_f32 v10, v36, v37
    v_cvt_pk_bf16_f32 v11, v38, v39
    v_cvt_pk_bf16_f32 v12, v40, v41
    v_cvt_pk_bf16_f32 v13, v42, v43
    v_cvt_pk_bf16_f32 v14, v44, v45
    v_cvt_pk_bf16_f32 v15, v46, v47
    v_mfma_f32_32x32x16_bf16 v[16:31], v[208:211], v[8:11], v[16:31]
    s_nop 0
    v_mfma_f32_32x32x16_bf16 v[16:31], v[212:215], v[12:15], v[16:31]
    v_mfma_f32_32x32x16_bf16 v[32:47], v[108:111], v[4:7], v[48:63]
    s_nop 11
    v_exp_f32 v32, v32
    v_exp_f32 v33, v33
    v_exp_f32 v34, v34
    v_exp_f32 v35, v35
    v_exp_f32 v36, v36
    v_exp_f32 v37, v37
    v_exp_f32 v38, v38
    v_exp_f32 v39, v39
    v_exp_f32 v40, v40
    v_exp_f32 v41, v41
    v_exp_f32 v42, v42
    v_exp_f32 v43, v43
    v_exp_f32 v44, v44
    v_exp_f32 v45, v45
    v_exp_f32 v46, v46
    v_exp_f32 v47, v47
    v_cvt_pk_bf16_f32 v8, v32, v33
    v_cvt_pk_bf16_f32 v9, v34, v35
    v_cvt_pk_bf16_f32 v10, v36, v37
    v_cvt_pk_bf16_f32 v11, v38, v39
    v_cvt_pk_bf16_f32 v12, v40, v41
    v_cvt_pk_bf16_f32 v13, v42, v43
    v_cvt_pk_bf16_f32 v14, v44, v45
    v_cvt_pk_bf16_f32 v15, v46, v47
    v_mfma_f32_32x32x16_bf16 v[16:31], v[216:219], v[8:11], v[16:31]
    s_nop 0
    v_mfma_f32_32x32x16_bf16 v[16:31], v[220:223], v[12:15], v[16:31]
    v_mfma_f32_32x32x16_bf16 v[32:47], v[112:115], v[4:7], v[48:63]
    s_nop 11
    v_exp_f32 v32, v32
    v_exp_f32 v33, v33
    v_exp_f32 v34, v34
    v_exp_f32 v35, v35
    v_exp_f32 v36, v36
    v_exp_f32 v37, v37
    v_exp_f32 v38, v38
    v_exp_f32 v39, v39
    v_exp_f32 v40, v40
    v_exp_f32 v41, v41
    v_exp_f32 v42, v42
    v_exp_f32 v43, v43
    v_exp_f32 v44, v44
    v_exp_f32 v45, v45
    v_exp_f32 v46, v46
    v_exp_f32 v47, v47
    v_cvt_pk_bf16_f32 v8, v32, v33
    v_cvt_pk_bf16_f32 v9, v34, v35
    v_cvt_pk_bf16_f32 v10, v36, v37
    v_cvt_pk_bf16_f32 v11, v38, v39
    v_cvt_pk_bf16_f32 v12, v40, v41
    v_cvt_pk_bf16_f32 v13, v42, v43
    v_cvt_pk_bf16_f32 v14, v44, v45
    v_cvt_pk_bf16_f32 v15, v46, v47
    v_mfma_f32_32x32x16_bf16 v[16:31], v[224:227], v[8:11], v[16:31]
    s_nop 0
    v_mfma_f32_32x32x16_bf16 v[16:31], v[228:231], v[12:15], v[16:31]
    v_mfma_f32_32x32x16_bf16 v[32:47], v[116:119], v[4:7], v[48:63]
    s_nop 11
    v_exp_f32 v32, v32
    v_exp_f32 v33, v33
    v_exp_f32 v34, v34
    v_exp_f32 v35, v35
    v_exp_f32 v36, v36
    v_exp_f32 v37, v37
    v_exp_f32 v38, v38
    v_exp_f32 v39, v39
    v_exp_f32 v40, v40
    v_exp_f32 v41, v41
    v_exp_f32 v42, v42
    v_exp_f32 v43, v43
    v_exp_f32 v44, v44
    v_exp_f32 v45, v45
    v_exp_f32 v46, v46
    v_exp_f32 v47, v47
    v_cvt_pk_bf16_f32 v8, v32, v33
    v_cvt_pk_bf16_f32 v9, v34, v35
    v_cvt_pk_bf16_f32 v10, v36, v37
    v_cvt_pk_bf16_f32 v11, v38, v39
    v_cvt_pk_bf16_f32 v12, v40, v41
    v_cvt_pk_bf16_f32 v13, v42, v43
    v_cvt_pk_bf16_f32 v14, v44, v45
    v_cvt_pk_bf16_f32 v15, v46, v47
    v_mfma_f32_32x32x16_bf16 v[16:31], v[232:235], v[8:11], v[16:31]
    s_nop 0
    v_mfma_f32_32x32x16_bf16 v[16:31], v[236:239], v[12:15], v[16:31]
    v_mfma_f32_32x32x16_bf16 v[32:47], v[120:123], v[4:7], v[48:63]
    s_nop 11
    v_exp_f32 v32, v32
    v_exp_f32 v33, v33
    v_exp_f32 v34, v34
    v_exp_f32 v35, v35
    v_exp_f32 v36, v36
    v_exp_f32 v37, v37
    v_exp_f32 v38, v38
    v_exp_f32 v39, v39
    v_exp_f32 v40, v40
    v_exp_f32 v41, v41
    v_exp_f32 v42, v42
    v_exp_f32 v43, v43
    v_exp_f32 v44, v44
    v_exp_f32 v45, v45
    v_exp_f32 v46, v46
    v_exp_f32 v47, v47
    v_cvt_pk_bf16_f32 v8, v32, v33
    v_cvt_pk_bf16_f32 v9, v34, v35
    v_cvt_pk_bf16_f32 v10, v36, v37
    v_cvt_pk_bf16_f32 v11, v38, v39
    v_cvt_pk_bf16_f32 v12, v40, v41
    v_cvt_pk_bf16_f32 v13, v42, v43
    v_cvt_pk_bf16_f32 v14, v44, v45
    v_cvt_pk_bf16_f32 v15, v46, v47
    v_mfma_f32_32x32x16_bf16 v[16:31], v[240:243], v[8:11], v[16:31]
    s_nop 0
    v_mfma_f32_32x32x16_bf16 v[16:31], v[244:247], v[12:15], v[16:31]
    v_mfma_f32_32x32x16_bf16 v[32:47], v[124:127], v[4:7], v[48:63]
    s_nop 11
    v_exp_f32 v32, v32
    v_exp_f32 v33, v33
    v_exp_f32 v34, v34
    v_exp_f32 v35, v35
    v_exp_f32 v36, v36
    v_exp_f32 v37, v37
    v_exp_f32 v38, v38
    v_exp_f32 v39, v39
    v_exp_f32 v40, v40
    v_exp_f32 v41, v41
    v_exp_f32 v42, v42
    v_exp_f32 v43, v43
    v_exp_f32 v44, v44
    v_exp_f32 v45, v45
    v_exp_f32 v46, v46
    v_exp_f32 v47, v47
    v_cvt_pk_bf16_f32 v8, v32, v33
    v_cvt_pk_bf16_f32 v9, v34, v35
    v_cvt_pk_bf16_f32 v10, v36, v37
    v_cvt_pk_bf16_f32 v11, v38, v39
    v_cvt_pk_bf16_f32 v12, v40, v41
    v_cvt_pk_bf16_f32 v13, v42, v43
    v_cvt_pk_bf16_f32 v14, v44, v45
    v_cvt_pk_bf16_f32 v15, v46, v47
    v_mfma_f32_32x32x16_bf16 v[16:31], v[248:251], v[8:11], v[16:31]
    s_nop 0
    v_mfma_f32_32x32x16_bf16 v[16:31], v[252:255], v[12:15], v[16:31]
    s_mov_b32 s98, 0
L_safe3:
    ds_read_b32 v32, v1
    s_add_u32 s98, s98, 1
    s_cmp_gt_u32 s98, 1048576
    s_cbranch_scc1 L_end
    s_waitcnt lgkmcnt(0)
    v_cmp_ne_u32 vcc, -1, v32
    s_cbranch_vccnz L_safe3
    s_nop 3
    ds_write_b128 v3, v[16:19]
    ds_write_b128 v3, v[20:23] offset:1024
    ds_write_b32 v1, v24
    v_add_u32 v2, 1024, v2
    s_add_u32 s99, s99, 1
    s_cmp_lt_u32 s99, 8
    s_cbranch_scc1 L_safe2
    s_branch L_a_post
.section .rodata,"a"
.p2align 6
.amdhsa_kernel adaLN_cond__grouped_kv_mqa__dense_activation_silu__prompt_kernel
  .amdhsa_next_free_vgpr 256
  .amdhsa_next_free_sgpr 102
  .amdhsa_accum_offset 256
  .amdhsa_group_segment_fixed_size 0
  .amdhsa_kernarg_size 104
  .amdhsa_user_sgpr_count 2
  .amdhsa_user_sgpr_kernarg_segment_ptr 1
  .amdhsa_system_sgpr_workgroup_id_x 1
.end_amdhsa_kernel
```
